```python
import torch

def _softmax(x, axis=-1):
    return torch.softmax(x, dim=axis)
def _gelu(x):
    return torch.nn.functional.gelu(x, approximate="tanh")
def _silu(x):
    return torch.nn.functional.silu(x)
def _sigmoid(x):
    return torch.sigmoid(x)
def _layernorm(x, axis=-1, eps=1e-5):
    m = x.mean(dim=axis, keepdim=True)
    v = x.var(dim=axis, keepdim=True, unbiased=False)
    return (x - m) / torch.sqrt(v + eps)
def _scatter_add(tgt, idx, src, axis=0):
    return tgt.clone().index_add_(axis, idx, src)
def _segment_sum(src, seg, n):
    out = torch.zeros((n,) + src.shape[1:], dtype=src.dtype)
    return out.index_add_(0, seg, src)
def _pad(x, pw):
    flat = tuple(v for pair in reversed(pw) for v in pair)
    return torch.nn.functional.pad(x, flat)

kernel_name = 'gated_mix__softmax_full_mha__mixer_s_mlp__prompt'

def setup_inputs():

    _w = (lambda a: (lambda t: t.to(torch.bfloat16) if t.is_floating_point() else t)(torch.as_tensor(a)))
    def _A_setup():
        B, S, D = 1, 2048, 512
        return {
            "x": _w((lambda *s: torch.randn(*s, dtype=torch.bfloat16) * 0.05)(B, S, D)),
            "wqkv": _w((lambda *s: torch.randn(*s, dtype=torch.bfloat16) * 1.6)(D, 3 * D)),
            "wo": _w((lambda *s: torch.randn(*s, dtype=torch.bfloat16) * 0.1)(D, D)),
        }
    _A_in = _A_setup()

    def _B_setup():
        B, S, D, F = 1, 2048, 512, 1792
        return {
            "x":  _w((lambda *s: torch.randn(*s, dtype=torch.bfloat16) * 0.05)(B, S, D)),
            "w1": _w((lambda *s: torch.randn(*s, dtype=torch.bfloat16) * 3.2)(D, D) * (D ** -0.5)),
            "w2": _w((lambda *s: torch.randn(*s, dtype=torch.bfloat16) * 3.2)(D, D) * (D ** -0.5)),
            "w3": _w((lambda *s: torch.randn(*s, dtype=torch.bfloat16) * 3.2)(D, F) * (D ** -0.5)),
            "w4": _w((lambda *s: torch.randn(*s, dtype=torch.bfloat16) * 1.6)(F, D) * (F ** -0.5)),
        }
    _B_in = _B_setup()

    return {
        "A_x": _A_in["x"],
        "A_wqkv": _A_in["wqkv"],
        "A_wo": _A_in["wo"],
        "B_x": _B_in["x"],
        "B_w1": _B_in["w1"],
        "B_w2": _B_in["w2"],
        "B_w3": _B_in["w3"],
        "B_w4": _B_in["w4"],
        "gate_w": _w((lambda *s: torch.randn(*s, dtype=torch.bfloat16) * 0.05)(512) * 16.0),
    }

def reference(A_x, A_wqkv, A_wo, B_x, B_w1, B_w2, B_w3, B_w4, gate_w):
    def _A_ref(x, wqkv, wo):
        B, S, D = x.shape
        H = 32; Dh = D // H
        qkv = (lambda x, *d: x.permute(*d))((x @ wqkv).reshape(B, S, 3, H, Dh), 2, 0, 3, 1, 4)
        q, k, v = qkv[0], qkv[1], qkv[2]
        scale = Dh ** -0.5
        scores = torch.einsum("bhqd,bhkd->bhqk", q, k) * scale
        p = _softmax(scores, axis=-1)
        o = torch.einsum("bhqk,bhkd->bhqd", p, v)
        return (lambda x, *d: x.permute(*d))(o, 0, 2, 1, 3).reshape(B, S, D) @ wo

    def _B_ref(x, w1, w2, w3, w4):
        B, S, D = x.shape
        h = _gelu(_layernorm(x, axis=-1) @ w1)
        c = D // 4
        g0 = _pad(h[:, :, 0*c:1*c], ((0, 0), (1, 0), (0, 0)))[:, :S, :]
        g1 = _pad(h[:, :, 1*c:2*c], ((0, 0), (0, 1), (0, 0)))[:, 1:, :]
        g2 = _pad(h[:, :, 2*c:3*c], ((0, 0), (2, 0), (0, 0)))[:, :S, :]
        g3 = _pad(h[:, :, 3*c:   ], ((0, 0), (0, 2), (0, 0)))[:, 2:, :]
        hs = torch.concatenate([g0, g1, g2, g3], axis=-1) @ w2
        x1 = x + hs
        h2 = _gelu(_layernorm(x1, axis=-1) @ w3) @ w4
        return x1 + h2

    x = A_x
    g = _sigmoid((x * gate_w).sum(-1, keepdims=True))
    a = _A_ref(x, A_wqkv, A_wo)
    b = _B_ref(x, B_w1, B_w2, B_w3, B_w4)
    return g * a + (1 - g) * b
```

```asm
; @launch grid=(256,1,1) block=(512,1,1) lds=161984
.amdgcn_target "amdgcn-amd-amdhsa--gfx950"
.text
.globl gated_mix__softmax_full_mha__mixer_s_mlp__prompt_kernel
.p2align 8
.type gated_mix__softmax_full_mha__mixer_s_mlp__prompt_kernel,@function
gated_mix__softmax_full_mha__mixer_s_mlp__prompt_kernel:
    s_cmp_ge_u32 s2, 256
    s_cbranch_scc1 L_mk_end
    s_load_dwordx16 s[4:19], s[0:1], 0
    s_load_dwordx8 s[20:27], s[0:1], 64
    v_lshrrev_b32 v2, 6, v0
    v_and_b32 v1, 63, v0
    v_readfirstlane_b32 s40, v2
    v_lshlrev_b32 v2, 4, v1
    s_and_b32 s41, s2, 1
    s_xor_b32 s41, s41, 1
    s_lshl_b32 s41, s41, 2
    s_bfe_u32 s42, s2, 0x20001
    s_or_b32 s41, s41, s42
    s_andn2_b32 s2, s2, 7
    s_or_b32 s2, s2, s41
    s_cmp_lg_u32 s40, 0
    s_cbranch_scc1 L_mk_nowarm
    s_getpc_b64 s[28:29]
L_mk_pc:
    s_sub_u32 s28, s28, L_mk_pc-gated_mix__softmax_full_mha__mixer_s_mlp__prompt_kernel
    s_subb_u32 s29, s29, 0
    s_mov_b32 s30, L_text_end-gated_mix__softmax_full_mha__mixer_s_mlp__prompt_kernel
    s_mov_b32 s31, 0x00020000
    s_bfe_u32 s45, s2, 0x30003
    s_lshl_b32 s45, s45, 13
    v_lshlrev_b32 v150, 7, v1
    buffer_load_dword v149, v150, s[28:31], s45 offen
L_mk_nowarm:
    s_and_b32 s41, s2, 7
    s_lshr_b32 s42, s2, 3
    s_and_b32 s43, s41, 3
    s_lshl_b32 s43, s43, 3
    s_and_b32 s68, s42, 7
    s_add_u32 s43, s43, s68
    s_lshr_b32 s44, s41, 2
    s_lshl_b32 s44, s44, 2
    s_lshr_b32 s45, s42, 3
    s_add_u32 s44, s44, s45
    s_lshl_b32 s45, s45, 1
    s_add_u32 s68, s68, s45
    s_and_b32 s68, s68, 6
    s_and_b32 s3, s40, 3
    s_cmp_lt_u32 s40, 4
    s_cbranch_scc1 L_mk_compute
    s_mov_b32 s46, 3072
    s_lshl_b32 s47, s3, 10
    s_mov_b32 s34, 0x180000
    s_cmp_eq_u32 s3, 3
    s_cselect_b32 s46, 1024, s46
    s_lshl_b32 s51, s44, 7
    s_add_u32 s47, s47, s51
    s_lshl_b32 s49, s46, 6
    s_lshl_b32 s50, s3, 13
    s_add_u32 s50, s50, 65536
    s_lshl_b32 s48, s43, 16
    s_cmp_eq_u32 s3, 3
    s_cselect_b32 s47, s48, s47
    s_cselect_b32 s49, 128, s49
    s_cselect_b32 s50, 0, s50
    s_cselect_b32 s34, 0x200000, s34
    s_cselect_b32 s52, 64, 0
    s_cselect_b64 vcc, -1, 0
    s_mov_b32 s62, s68
    v_lshrrev_b32 v136, 3, v1
    v_and_b32 v138, 7, v1
    v_lshrrev_b32 v137, 4, v1
    v_lshrrev_b32 v139, 2, v1
    v_and_b32 v139, 4, v139
    v_cndmask_b32 v137, v139, v137, vcc
    v_mul_lo_u32 v136, v136, s46
    v_xor_b32 v137, v137, v138
    v_lshl_add_u32 v8, v137, 4, v136
    s_lshl_b32 s53, s46, 3
    s_sub_u32 s53, s53, 1024
    v_xor_b32 v9, s52, v8
    v_add_u32 v9, s53, v9
    s_lshl_b32 s53, s53, 1
    v_add_u32 v10, s53, v8
    v_add_u32 v11, s53, v9
    s_lshl_b32 s53, s46, 5
    s_mov_b32 s35, 0x00020000
    s_cmp_eq_u32 s3, 3
    s_waitcnt lgkmcnt(0)
    s_cselect_b32 s32, s4, s6
    s_cselect_b32 s33, s5, s7
    s_mov_b32 s54, 0
    s_cmp_eq_u32 s3, 3
    s_cselect_b32 s54, 0, s54
    s_add_u32 s54, s54, s50
    s_mul_i32 s69, s68, s49
    s_add_u32 s69, s69, s47
    s_add_u32 m0, s54, 0
    s_nop 0
    buffer_load_dwordx4 v8, s[32:35], s69 offen offset:0 lds
    buffer_load_dwordx4 v9, s[32:35], s69 offen offset:1024 lds
    buffer_load_dwordx4 v10, s[32:35], s69 offen offset:2048 lds
    buffer_load_dwordx4 v11, s[32:35], s69 offen offset:3072 lds
    s_add_u32 m0, s54, 4096
    s_add_u32 s69, s69, s53
    buffer_load_dwordx4 v8, s[32:35], s69 offen offset:0 lds
    buffer_load_dwordx4 v9, s[32:35], s69 offen offset:1024 lds
    buffer_load_dwordx4 v10, s[32:35], s69 offen offset:2048 lds
    buffer_load_dwordx4 v11, s[32:35], s69 offen offset:3072 lds
    s_add_u32 s68, s68, 1
    s_and_b32 s68, s68, 7
    s_mov_b32 s54, 24576
    s_cmp_eq_u32 s3, 3
    s_cselect_b32 s54, 8192, s54
    s_add_u32 s54, s54, s50
    s_mul_i32 s69, s68, s49
    s_add_u32 s69, s69, s47
    s_add_u32 m0, s54, 0
    s_nop 0
    buffer_load_dwordx4 v8, s[32:35], s69 offen offset:0 lds
    buffer_load_dwordx4 v9, s[32:35], s69 offen offset:1024 lds
    buffer_load_dwordx4 v10, s[32:35], s69 offen offset:2048 lds
    buffer_load_dwordx4 v11, s[32:35], s69 offen offset:3072 lds
    s_add_u32 m0, s54, 4096
    s_add_u32 s69, s69, s53
    buffer_load_dwordx4 v8, s[32:35], s69 offen offset:0 lds
    buffer_load_dwordx4 v9, s[32:35], s69 offen offset:1024 lds
    buffer_load_dwordx4 v10, s[32:35], s69 offen offset:2048 lds
    buffer_load_dwordx4 v11, s[32:35], s69 offen offset:3072 lds
    s_add_u32 s68, s68, 1
    s_and_b32 s68, s68, 7
    s_mov_b32 s36, s26
    s_mov_b32 s37, s27
    s_mov_b32 s38, 0x2000000
    s_mov_b32 s39, 0x00020000
    s_mov_b32 s28, s12
    s_mov_b32 s29, s13
    s_mov_b32 s30, 0x80000
    s_mov_b32 s31, 0x00020000
    v_lshrrev_b32 v136, 3, v1
    v_lshlrev_b32 v136, 10, v136
    v_xor_b32 v137, v139, v138
    v_lshl_add_u32 v4, v137, 4, v136
    v_add_u32 v5, 7168, v4
    v_add_u32 v6, 7168, v5
    v_add_u32 v7, 7168, v6
    s_mov_b32 s11, 0x00020000
    s_mov_b32 s58, 1024
    s_mov_b32 s60, 32768
    s_mov_b32 s61, 0x7f000000
    s_mov_b32 s10, 0x80000
    s_cmp_ge_u32 s3, 2
    s_cbranch_scc1 L_mk_rp_w2
    s_cmp_lt_u32 s2, 112
    s_cbranch_scc1 L_mk_rp_w3
    s_cmp_lt_u32 s2, 224
    s_cbranch_scc1 L_mk_rp_w4
    s_mov_b32 s59, 0x880000
    s_bfe_u32 s56, s2, 0x20003
    s_and_b32 s57, s2, 7
    s_mov_b32 s55, 8
    s_mov_b32 s64, 7
    s_branch L_mk_rp_go
L_mk_rp_w3:
    s_mov_b32 s8, s16
    s_mov_b32 s9, s17
    s_mov_b32 s10, 0x1c0000
    s_mul_i32 s56, s2, 2341
    s_lshr_b32 s56, s56, 16
    s_mul_i32 s57, s56, 28
    s_sub_u32 s57, s2, s57
    s_mov_b32 s58, 3584
    s_mov_b32 s55, 24
    s_mov_b32 s64, 7
    s_mov_b32 s59, 0x900000
    s_lshl_b32 s61, s57, 11
    s_lshl_b32 s63, s3, 10
    s_add_u32 s61, s61, s63
    s_lshr_b32 s63, s56, 1
    s_lshl_b32 s63, s63, 9
    s_add_u32 s61, s61, s63
    s_and_b32 s63, s56, 1
    s_lshl_b32 s63, s63, 3
    s_add_u32 s61, s61, s63
    s_add_u32 s61, s61, 0xd00000
    s_branch L_mk_rp_go
L_mk_rp_w4:
    s_mov_b32 s8, s18
    s_mov_b32 s9, s19
    s_mov_b32 s10, 0x1c0000
    s_sub_u32 s55, s2, 112
    s_lshr_b32 s56, s55, 3
    s_and_b32 s57, s55, 7
    s_mov_b32 s59, 0xb00000
    s_mov_b32 s55, 16
    s_mov_b32 s64, 2
    s_mov_b32 s60, 114688
L_mk_rp_go:
    s_add_u32 s55, s55, s57
    s_lshl_b32 s57, s57, 1
    s_add_u32 s57, s57, s3
    s_mul_i32 s63, s57, s60
    s_add_u32 s59, s59, s63
    s_lshl_b32 s63, s56, 13
    s_add_u32 s59, s59, s63
    s_lshl_b32 s63, s58, 7
    s_mul_i32 s65, s56, s63
    s_lshl_b32 s63, s57, 6
    s_add_u32 s65, s65, s63
    s_branch L_mk_rp_j
L_mk_rp_w2:
    s_mov_b32 s8, s14
    s_mov_b32 s9, s15
    s_lshl_b32 s56, s2, 1
    s_add_u32 s56, s56, s3
    s_sub_u32 s56, s56, 2
    s_lshl_b32 s59, s56, 10
    s_add_u32 s59, s59, 0x800000
    s_and_b32 s65, s56, 31
    s_lshl_b32 s65, s65, 14
    s_lshr_b32 s63, s56, 5
    s_lshl_b32 s63, s63, 6
    s_add_u32 s65, s65, s63
    s_lshr_b32 s55, s2, 5
    s_mov_b32 s64, 1
L_mk_rp_j:
    s_lshl_b32 s55, s55, 8
    s_add_u32 s55, s55, 0xd8b000
    s_lshl_b32 s66, s58, 4
    s_lshl_b32 s67, s3, 13
    s_lshl_b32 s63, s3, 10
    s_add_u32 s63, s63, 14336
    s_cmp_ge_u32 s3, 2
    s_cselect_b32 s67, s63, s67
    s_add_u32 s67, s67, 139264
    v_lshrrev_b32 v136, 2, v1
    v_mul_lo_u32 v136, v136, s58
    v_and_b32 v137, 3, v1
    v_lshl_add_u32 v16, v137, 4, v136
    v_lshrrev_b32 v137, 5, v1
    v_lshlrev_b32 v17, 8, v137
    v_bfe_u32 v136, v1, 2, 2
    v_lshl_add_u32 v17, v136, 6, v17
    v_bfe_u32 v136, v1, 4, 1
    v_lshl_add_u32 v17, v136, 5, v17
    v_and_b32 v136, 3, v1
    v_lshl_add_u32 v17, v136, 3, v17
    v_add_u32 v17, s67, v17
    s_cmp_ge_u32 s3, 2
    s_cbranch_scc1 L_mk_idle
    s_waitcnt vmcnt(8)
    s_barrier
    s_mov_b32 s54, 49152
    s_cmp_eq_u32 s3, 3
    s_cselect_b32 s54, 16384, s54
    s_add_u32 s54, s54, s50
    s_mul_i32 s69, s68, s49
    s_add_u32 s69, s69, s47
    s_add_u32 m0, s54, 0
    s_nop 0
    buffer_load_dwordx4 v8, s[32:35], s69 offen offset:0 lds
    buffer_load_dwordx4 v9, s[32:35], s69 offen offset:1024 lds
    buffer_load_dwordx4 v10, s[32:35], s69 offen offset:2048 lds
    buffer_load_dwordx4 v11, s[32:35], s69 offen offset:3072 lds
    s_add_u32 m0, s54, 4096
    s_add_u32 s69, s69, s53
    buffer_load_dwordx4 v8, s[32:35], s69 offen offset:0 lds
    buffer_load_dwordx4 v9, s[32:35], s69 offen offset:1024 lds
    buffer_load_dwordx4 v10, s[32:35], s69 offen offset:2048 lds
    buffer_load_dwordx4 v11, s[32:35], s69 offen offset:3072 lds
    s_add_u32 s68, s68, 1
    s_and_b32 s68, s68, 7
    s_waitcnt vmcnt(8)
    s_barrier
    s_mov_b32 s54, 0
    s_cmp_eq_u32 s3, 3
    s_cselect_b32 s54, 24576, s54
    s_add_u32 s54, s54, s50
    s_mul_i32 s69, s68, s49
    s_add_u32 s69, s69, s47
    s_add_u32 m0, s54, 0
    s_nop 0
    buffer_load_dwordx4 v8, s[32:35], s69 offen offset:0 lds
    buffer_load_dwordx4 v9, s[32:35], s69 offen offset:1024 lds
    buffer_load_dwordx4 v10, s[32:35], s69 offen offset:2048 lds
    buffer_load_dwordx4 v11, s[32:35], s69 offen offset:3072 lds
    s_add_u32 m0, s54, 4096
    s_add_u32 s69, s69, s53
    buffer_load_dwordx4 v8, s[32:35], s69 offen offset:0 lds
    buffer_load_dwordx4 v9, s[32:35], s69 offen offset:1024 lds
    buffer_load_dwordx4 v10, s[32:35], s69 offen offset:2048 lds
    buffer_load_dwordx4 v11, s[32:35], s69 offen offset:3072 lds
    s_add_u32 s68, s68, 1
    s_and_b32 s68, s68, 7
    s_waitcnt vmcnt(8)
    s_barrier
    s_mov_b32 s54, 24576
    s_cmp_eq_u32 s3, 3
    s_cselect_b32 s54, 32768, s54
    s_add_u32 s54, s54, s50
    s_mul_i32 s69, s68, s49
    s_add_u32 s69, s69, s47
    s_add_u32 m0, s54, 0
    s_nop 0
    buffer_load_dwordx4 v8, s[32:35], s69 offen offset:0 lds
    buffer_load_dwordx4 v9, s[32:35], s69 offen offset:1024 lds
    buffer_load_dwordx4 v10, s[32:35], s69 offen offset:2048 lds
    buffer_load_dwordx4 v11, s[32:35], s69 offen offset:3072 lds
    s_add_u32 m0, s54, 4096
    s_add_u32 s69, s69, s53
    buffer_load_dwordx4 v8, s[32:35], s69 offen offset:0 lds
    buffer_load_dwordx4 v9, s[32:35], s69 offen offset:1024 lds
    buffer_load_dwordx4 v10, s[32:35], s69 offen offset:2048 lds
    buffer_load_dwordx4 v11, s[32:35], s69 offen offset:3072 lds
    s_add_u32 s68, s68, 1
    s_and_b32 s68, s68, 7
    s_waitcnt vmcnt(8)
    s_barrier
    v_mov_b32 v12, 0
    global_load_dword v13, v12, s[24:25] sc1
    s_mov_b32 s54, 49152
    s_cmp_eq_u32 s3, 3
    s_cselect_b32 s54, 40960, s54
    s_add_u32 s54, s54, s50
    s_mul_i32 s69, s68, s49
    s_add_u32 s69, s69, s47
    s_add_u32 m0, s54, 0
    s_nop 0
    buffer_load_dwordx4 v8, s[32:35], s69 offen offset:0 lds
    buffer_load_dwordx4 v9, s[32:35], s69 offen offset:1024 lds
    buffer_load_dwordx4 v10, s[32:35], s69 offen offset:2048 lds
    buffer_load_dwordx4 v11, s[32:35], s69 offen offset:3072 lds
    s_add_u32 m0, s54, 4096
    s_add_u32 s69, s69, s53
    buffer_load_dwordx4 v8, s[32:35], s69 offen offset:0 lds
    buffer_load_dwordx4 v9, s[32:35], s69 offen offset:1024 lds
    buffer_load_dwordx4 v10, s[32:35], s69 offen offset:2048 lds
    buffer_load_dwordx4 v11, s[32:35], s69 offen offset:3072 lds
    s_add_u32 s68, s68, 1
    s_and_b32 s68, s68, 7
    s_waitcnt vmcnt(9)
    s_barrier
    s_mov_b32 s54, 0
    s_cmp_eq_u32 s3, 3
    s_cselect_b32 s54, 49152, s54
    s_add_u32 s54, s54, s50
    s_mul_i32 s69, s68, s49
    s_add_u32 s69, s69, s47
    s_add_u32 m0, s54, 0
    s_nop 0
    buffer_load_dwordx4 v8, s[32:35], s69 offen offset:0 lds
    buffer_load_dwordx4 v9, s[32:35], s69 offen offset:1024 lds
    buffer_load_dwordx4 v10, s[32:35], s69 offen offset:2048 lds
    buffer_load_dwordx4 v11, s[32:35], s69 offen offset:3072 lds
    s_add_u32 m0, s54, 4096
    s_add_u32 s69, s69, s53
    buffer_load_dwordx4 v8, s[32:35], s69 offen offset:0 lds
    buffer_load_dwordx4 v9, s[32:35], s69 offen offset:1024 lds
    buffer_load_dwordx4 v10, s[32:35], s69 offen offset:2048 lds
    buffer_load_dwordx4 v11, s[32:35], s69 offen offset:3072 lds
    s_add_u32 s68, s68, 1
    s_and_b32 s68, s68, 7
    s_waitcnt vmcnt(8)
    s_barrier
    s_mov_b32 s45, 0x40000
L_mk_zpa:
    v_readfirstlane_b32 s99, v13
    s_sub_u32 s45, s45, 1
    s_cmp_eq_u32 s45, 0
    s_cbranch_scc1 L_mk_zseta
    s_cmp_lg_u32 s99, 0
    s_cbranch_scc1 L_mk_zseta
    s_sleep 4
    global_load_dword v13, v12, s[24:25] sc1
    s_waitcnt vmcnt(0)
    s_branch L_mk_zpa
L_mk_zseta:
    s_mov_b32 s54, 24576
    s_cmp_eq_u32 s3, 3
    s_cselect_b32 s54, 57344, s54
    s_add_u32 s54, s54, s50
    s_mul_i32 s69, s68, s49
    s_add_u32 s69, s69, s47
    s_add_u32 m0, s54, 0
    s_nop 0
    buffer_load_dwordx4 v8, s[32:35], s69 offen offset:0 lds
    buffer_load_dwordx4 v9, s[32:35], s69 offen offset:1024 lds
    buffer_load_dwordx4 v10, s[32:35], s69 offen offset:2048 lds
    buffer_load_dwordx4 v11, s[32:35], s69 offen offset:3072 lds
    s_add_u32 m0, s54, 4096
    s_add_u32 s69, s69, s53
    buffer_load_dwordx4 v8, s[32:35], s69 offen offset:0 lds
    buffer_load_dwordx4 v9, s[32:35], s69 offen offset:1024 lds
    buffer_load_dwordx4 v10, s[32:35], s69 offen offset:2048 lds
    buffer_load_dwordx4 v11, s[32:35], s69 offen offset:3072 lds
    s_add_u32 s68, s68, 1
    s_and_b32 s68, s68, 7
    s_waitcnt vmcnt(8)
    s_barrier
    s_lshl_b32 s54, s3, 12
    s_add_u32 m0, s54, 114688
    s_lshl_b32 s69, s62, 16
    s_add_u32 s69, s69, s51
    s_lshl_b32 s54, s3, 15
    s_add_u32 s69, s69, s54
    buffer_load_dwordx4 v4, s[28:31], s69 offen offset:0 lds
    buffer_load_dwordx4 v5, s[28:31], s69 offen offset:1024 lds
    buffer_load_dwordx4 v6, s[28:31], s69 offen offset:2048 lds
    buffer_load_dwordx4 v7, s[28:31], s69 offen offset:3072 lds
    s_add_u32 s62, s62, 1
    s_and_b32 s62, s62, 7
    s_lshl_b32 s54, s3, 12
    s_add_u32 m0, s54, 122880
    s_lshl_b32 s69, s62, 16
    s_add_u32 s69, s69, s51
    s_lshl_b32 s54, s3, 15
    s_add_u32 s69, s69, s54
    buffer_load_dwordx4 v4, s[28:31], s69 offen offset:0 lds
    buffer_load_dwordx4 v5, s[28:31], s69 offen offset:1024 lds
    buffer_load_dwordx4 v6, s[28:31], s69 offen offset:2048 lds
    buffer_load_dwordx4 v7, s[28:31], s69 offen offset:3072 lds
    s_add_u32 s62, s62, 1
    s_and_b32 s62, s62, 7
    s_lshl_b32 s54, s3, 12
    s_add_u32 m0, s54, 131072
    s_lshl_b32 s69, s62, 16
    s_add_u32 s69, s69, s51
    s_lshl_b32 s54, s3, 15
    s_add_u32 s69, s69, s54
    buffer_load_dwordx4 v4, s[28:31], s69 offen offset:0 lds
    buffer_load_dwordx4 v5, s[28:31], s69 offen offset:1024 lds
    buffer_load_dwordx4 v6, s[28:31], s69 offen offset:2048 lds
    buffer_load_dwordx4 v7, s[28:31], s69 offen offset:3072 lds
    s_add_u32 s62, s62, 1
    s_and_b32 s62, s62, 7
    s_waitcnt vmcnt(12)
    s_barrier
    s_lshl_b32 s54, s3, 12
    s_add_u32 m0, s54, 65536
    s_lshl_b32 s69, s62, 16
    s_add_u32 s69, s69, s51
    s_lshl_b32 s54, s3, 15
    s_add_u32 s69, s69, s54
    buffer_load_dwordx4 v4, s[28:31], s69 offen offset:0 lds
    buffer_load_dwordx4 v5, s[28:31], s69 offen offset:1024 lds
    buffer_load_dwordx4 v6, s[28:31], s69 offen offset:2048 lds
    buffer_load_dwordx4 v7, s[28:31], s69 offen offset:3072 lds
    s_add_u32 s62, s62, 1
    s_and_b32 s62, s62, 7
    s_lshl_b32 s54, s3, 12
    s_add_u32 m0, s54, 73728
    s_lshl_b32 s69, s62, 16
    s_add_u32 s69, s69, s51
    s_lshl_b32 s54, s3, 15
    s_add_u32 s69, s69, s54
    buffer_load_dwordx4 v4, s[28:31], s69 offen offset:0 lds
    buffer_load_dwordx4 v5, s[28:31], s69 offen offset:1024 lds
    buffer_load_dwordx4 v6, s[28:31], s69 offen offset:2048 lds
    buffer_load_dwordx4 v7, s[28:31], s69 offen offset:3072 lds
    s_add_u32 s62, s62, 1
    s_and_b32 s62, s62, 7
    s_lshl_b32 s54, s3, 12
    s_add_u32 m0, s54, 81920
    s_lshl_b32 s69, s62, 16
    s_add_u32 s69, s69, s51
    s_lshl_b32 s54, s3, 15
    s_add_u32 s69, s69, s54
    buffer_load_dwordx4 v4, s[28:31], s69 offen offset:0 lds
    buffer_load_dwordx4 v5, s[28:31], s69 offen offset:1024 lds
    buffer_load_dwordx4 v6, s[28:31], s69 offen offset:2048 lds
    buffer_load_dwordx4 v7, s[28:31], s69 offen offset:3072 lds
    s_add_u32 s62, s62, 1
    s_and_b32 s62, s62, 7
    s_barrier
    s_lshl_b32 s54, s3, 12
    s_add_u32 m0, s54, 90112
    s_lshl_b32 s69, s62, 16
    s_add_u32 s69, s69, s51
    s_lshl_b32 s54, s3, 15
    s_add_u32 s69, s69, s54
    buffer_load_dwordx4 v4, s[28:31], s69 offen offset:0 lds
    buffer_load_dwordx4 v5, s[28:31], s69 offen offset:1024 lds
    buffer_load_dwordx4 v6, s[28:31], s69 offen offset:2048 lds
    buffer_load_dwordx4 v7, s[28:31], s69 offen offset:3072 lds
    s_add_u32 s62, s62, 1
    s_and_b32 s62, s62, 7
    s_lshl_b32 s54, s3, 12
    s_add_u32 m0, s54, 98304
    s_lshl_b32 s69, s62, 16
    s_add_u32 s69, s69, s51
    s_lshl_b32 s54, s3, 15
    s_add_u32 s69, s69, s54
    buffer_load_dwordx4 v4, s[28:31], s69 offen offset:0 lds
    buffer_load_dwordx4 v5, s[28:31], s69 offen offset:1024 lds
    buffer_load_dwordx4 v6, s[28:31], s69 offen offset:2048 lds
    buffer_load_dwordx4 v7, s[28:31], s69 offen offset:3072 lds
    s_add_u32 s62, s62, 1
    s_and_b32 s62, s62, 7
    s_add_u32 m0, s67, 0
    s_nop 0
    buffer_load_dwordx4 v16, s[8:11], s65 offen lds
    s_add_u32 s65, s65, s66
    s_add_u32 m0, s67, 1024
    s_nop 0
    buffer_load_dwordx4 v16, s[8:11], s65 offen lds
    s_add_u32 s65, s65, s66
    s_add_u32 m0, s67, 2048
    s_nop 0
    buffer_load_dwordx4 v16, s[8:11], s65 offen lds
    s_add_u32 s65, s65, s66
    s_add_u32 m0, s67, 3072
    s_nop 0
    buffer_load_dwordx4 v16, s[8:11], s65 offen lds
    s_add_u32 s65, s65, s66
    s_add_u32 m0, s67, 4096
    s_nop 0
    buffer_load_dwordx4 v16, s[8:11], s65 offen lds
    s_add_u32 s65, s65, s66
    s_add_u32 m0, s67, 5120
    s_nop 0
    buffer_load_dwordx4 v16, s[8:11], s65 offen lds
    s_add_u32 s65, s65, s66
    s_add_u32 m0, s67, 6144
    s_nop 0
    buffer_load_dwordx4 v16, s[8:11], s65 offen lds
    s_add_u32 s65, s65, s66
    s_add_u32 m0, s67, 7168
    s_nop 0
    buffer_load_dwordx4 v16, s[8:11], s65 offen lds
    s_add_u32 s65, s65, s66
    s_waitcnt vmcnt(16)
    s_barrier
    s_waitcnt vmcnt(8)
    s_barrier
    s_waitcnt vmcnt(0)
    ds_read_b64_tr_b16 v[20:21], v17 offset:0
    ds_read_b64_tr_b16 v[22:23], v17 offset:512
    ds_read_b64_tr_b16 v[24:25], v17 offset:1024
    ds_read_b64_tr_b16 v[26:27], v17 offset:1536
    ds_read_b64_tr_b16 v[28:29], v17 offset:2048
    ds_read_b64_tr_b16 v[30:31], v17 offset:2560
    ds_read_b64_tr_b16 v[32:33], v17 offset:3072
    ds_read_b64_tr_b16 v[34:35], v17 offset:3584
    ds_read_b64_tr_b16 v[36:37], v17 offset:4096
    ds_read_b64_tr_b16 v[38:39], v17 offset:4608
    ds_read_b64_tr_b16 v[40:41], v17 offset:5120
    ds_read_b64_tr_b16 v[42:43], v17 offset:5632
    ds_read_b64_tr_b16 v[44:45], v17 offset:6144
    ds_read_b64_tr_b16 v[46:47], v17 offset:6656
    s_waitcnt lgkmcnt(8)
    ds_read_b64_tr_b16 v[48:49], v17 offset:7168
    ds_read_b64_tr_b16 v[50:51], v17 offset:7680
    s_mov_b32 s12, s59
    s_mov_b32 s13, s61
    s_mov_b32 s14, s55
    s_mov_b32 s15, s64
    v_mov_b32 v52, 0x3f803f80
    v_mov_b32 v53, 0
    s_waitcnt lgkmcnt(0)
    v_mov_b32 v14, 161844
    v_mov_b32 v15, 1
    s_mov_b64 exec, 1
    ds_add_u32 v14, v15
    s_mov_b64 exec, -1
    s_cmp_ge_u32 s2, 112
    s_cbranch_scc1 L_mk_ldone
    v_dot2_f32_bf16 v53, v20, v52, v53
    v_dot2_f32_bf16 v53, v21, v52, v53
    v_dot2_f32_bf16 v53, v22, v52, v53
    v_dot2_f32_bf16 v53, v23, v52, v53
    v_dot2_f32_bf16 v53, v24, v52, v53
    v_dot2_f32_bf16 v53, v25, v52, v53
    v_dot2_f32_bf16 v53, v26, v52, v53
    v_dot2_f32_bf16 v53, v27, v52, v53
    v_dot2_f32_bf16 v53, v28, v52, v53
    v_dot2_f32_bf16 v53, v29, v52, v53
    v_dot2_f32_bf16 v53, v30, v52, v53
    v_dot2_f32_bf16 v53, v31, v52, v53
    v_dot2_f32_bf16 v53, v32, v52, v53
    v_dot2_f32_bf16 v53, v33, v52, v53
    v_dot2_f32_bf16 v53, v34, v52, v53
    v_dot2_f32_bf16 v53, v35, v52, v53
    v_dot2_f32_bf16 v53, v36, v52, v53
    v_dot2_f32_bf16 v53, v37, v52, v53
    v_dot2_f32_bf16 v53, v38, v52, v53
    v_dot2_f32_bf16 v53, v39, v52, v53
    v_dot2_f32_bf16 v53, v40, v52, v53
    v_dot2_f32_bf16 v53, v41, v52, v53
    v_dot2_f32_bf16 v53, v42, v52, v53
    v_dot2_f32_bf16 v53, v43, v52, v53
    v_dot2_f32_bf16 v53, v44, v52, v53
    v_dot2_f32_bf16 v53, v45, v52, v53
    v_dot2_f32_bf16 v53, v46, v52, v53
    v_dot2_f32_bf16 v53, v47, v52, v53
    v_dot2_f32_bf16 v53, v48, v52, v53
    v_dot2_f32_bf16 v53, v49, v52, v53
    v_dot2_f32_bf16 v53, v50, v52, v53
    v_dot2_f32_bf16 v53, v51, v52, v53
    s_nop 2
    v_mov_b32 v14, v53
    s_nop 1
    v_permlane32_swap_b32 v14, v53
    s_nop 1
    v_add_f32 v14, v14, v53
    v_cvt_pk_bf16_f32 v53, v14, 0
    v_lshlrev_b32 v15, 16, v53
    v_sub_f32 v15, v14, v15
    v_cvt_pk_bf16_f32 v52, v14, v15
    s_branch L_mk_ldone
L_mk_idle:
    s_mov_b32 m0, s67
    s_nop 0
    buffer_load_dwordx4 v16, s[8:11], s65 offen lds
    s_waitcnt vmcnt(9)
    s_barrier
    s_mov_b32 s54, 49152
    s_cmp_eq_u32 s3, 3
    s_cselect_b32 s54, 16384, s54
    s_add_u32 s54, s54, s50
    s_mul_i32 s69, s68, s49
    s_add_u32 s69, s69, s47
    s_add_u32 m0, s54, 0
    s_nop 0
    buffer_load_dwordx4 v8, s[32:35], s69 offen offset:0 lds
    buffer_load_dwordx4 v9, s[32:35], s69 offen offset:1024 lds
    buffer_load_dwordx4 v10, s[32:35], s69 offen offset:2048 lds
    buffer_load_dwordx4 v11, s[32:35], s69 offen offset:3072 lds
    s_add_u32 m0, s54, 4096
    s_add_u32 s69, s69, s53
    buffer_load_dwordx4 v8, s[32:35], s69 offen offset:0 lds
    buffer_load_dwordx4 v9, s[32:35], s69 offen offset:1024 lds
    buffer_load_dwordx4 v10, s[32:35], s69 offen offset:2048 lds
    buffer_load_dwordx4 v11, s[32:35], s69 offen offset:3072 lds
    s_add_u32 s68, s68, 1
    s_and_b32 s68, s68, 7
    s_waitcnt vmcnt(9)
    s_barrier
    s_mov_b32 s54, 0
    s_cmp_eq_u32 s3, 3
    s_cselect_b32 s54, 24576, s54
    s_add_u32 s54, s54, s50
    s_mul_i32 s69, s68, s49
    s_add_u32 s69, s69, s47
    s_add_u32 m0, s54, 0
    s_nop 0
    buffer_load_dwordx4 v8, s[32:35], s69 offen offset:0 lds
    buffer_load_dwordx4 v9, s[32:35], s69 offen offset:1024 lds
    buffer_load_dwordx4 v10, s[32:35], s69 offen offset:2048 lds
    buffer_load_dwordx4 v11, s[32:35], s69 offen offset:3072 lds
    s_add_u32 m0, s54, 4096
    s_add_u32 s69, s69, s53
    buffer_load_dwordx4 v8, s[32:35], s69 offen offset:0 lds
    buffer_load_dwordx4 v9, s[32:35], s69 offen offset:1024 lds
    buffer_load_dwordx4 v10, s[32:35], s69 offen offset:2048 lds
    buffer_load_dwordx4 v11, s[32:35], s69 offen offset:3072 lds
    s_add_u32 s68, s68, 1
    s_and_b32 s68, s68, 7
    s_waitcnt vmcnt(8)
    s_barrier
    ds_read_b64_tr_b16 v[20:21], v17 offset:0
    ds_read_b64_tr_b16 v[22:23], v17 offset:512
    s_waitcnt lgkmcnt(0)
    buffer_store_dwordx4 v[20:23], v2, s[36:39], s59 offen sc1
    s_mov_b32 s54, 24576
    s_cmp_eq_u32 s3, 3
    s_cselect_b32 s54, 32768, s54
    s_add_u32 s54, s54, s50
    s_mul_i32 s69, s68, s49
    s_add_u32 s69, s69, s47
    s_add_u32 m0, s54, 0
    s_nop 0
    buffer_load_dwordx4 v8, s[32:35], s69 offen offset:0 lds
    buffer_load_dwordx4 v9, s[32:35], s69 offen offset:1024 lds
    buffer_load_dwordx4 v10, s[32:35], s69 offen offset:2048 lds
    buffer_load_dwordx4 v11, s[32:35], s69 offen offset:3072 lds
    s_add_u32 m0, s54, 4096
    s_add_u32 s69, s69, s53
    buffer_load_dwordx4 v8, s[32:35], s69 offen offset:0 lds
    buffer_load_dwordx4 v9, s[32:35], s69 offen offset:1024 lds
    buffer_load_dwordx4 v10, s[32:35], s69 offen offset:2048 lds
    buffer_load_dwordx4 v11, s[32:35], s69 offen offset:3072 lds
    s_add_u32 s68, s68, 1
    s_and_b32 s68, s68, 7
    s_waitcnt vmcnt(9)
    s_barrier
    v_mov_b32 v12, 0
    global_load_dword v13, v12, s[24:25] sc1
    s_mov_b32 s54, 49152
    s_cmp_eq_u32 s3, 3
    s_cselect_b32 s54, 40960, s54
    s_add_u32 s54, s54, s50
    s_mul_i32 s69, s68, s49
    s_add_u32 s69, s69, s47
    s_add_u32 m0, s54, 0
    s_nop 0
    buffer_load_dwordx4 v8, s[32:35], s69 offen offset:0 lds
    buffer_load_dwordx4 v9, s[32:35], s69 offen offset:1024 lds
    buffer_load_dwordx4 v10, s[32:35], s69 offen offset:2048 lds
    buffer_load_dwordx4 v11, s[32:35], s69 offen offset:3072 lds
    s_add_u32 m0, s54, 4096
    s_add_u32 s69, s69, s53
    buffer_load_dwordx4 v8, s[32:35], s69 offen offset:0 lds
    buffer_load_dwordx4 v9, s[32:35], s69 offen offset:1024 lds
    buffer_load_dwordx4 v10, s[32:35], s69 offen offset:2048 lds
    buffer_load_dwordx4 v11, s[32:35], s69 offen offset:3072 lds
    s_add_u32 s68, s68, 1
    s_and_b32 s68, s68, 7
    s_waitcnt vmcnt(9)
    s_barrier
    s_mov_b32 s54, 0
    s_cmp_eq_u32 s3, 3
    s_cselect_b32 s54, 49152, s54
    s_add_u32 s54, s54, s50
    s_mul_i32 s69, s68, s49
    s_add_u32 s69, s69, s47
    s_add_u32 m0, s54, 0
    s_nop 0
    buffer_load_dwordx4 v8, s[32:35], s69 offen offset:0 lds
    buffer_load_dwordx4 v9, s[32:35], s69 offen offset:1024 lds
    buffer_load_dwordx4 v10, s[32:35], s69 offen offset:2048 lds
    buffer_load_dwordx4 v11, s[32:35], s69 offen offset:3072 lds
    s_add_u32 m0, s54, 4096
    s_add_u32 s69, s69, s53
    buffer_load_dwordx4 v8, s[32:35], s69 offen offset:0 lds
    buffer_load_dwordx4 v9, s[32:35], s69 offen offset:1024 lds
    buffer_load_dwordx4 v10, s[32:35], s69 offen offset:2048 lds
    buffer_load_dwordx4 v11, s[32:35], s69 offen offset:3072 lds
    s_add_u32 s68, s68, 1
    s_and_b32 s68, s68, 7
    s_waitcnt vmcnt(8)
    s_barrier
    s_mov_b32 s45, 0x40000
L_mk_zpi:
    v_readfirstlane_b32 s99, v13
    s_sub_u32 s45, s45, 1
    s_cmp_eq_u32 s45, 0
    s_cbranch_scc1 L_mk_zseti
    s_cmp_lg_u32 s99, 0
    s_cbranch_scc1 L_mk_zseti
    s_sleep 4
    global_load_dword v13, v12, s[24:25] sc1
    s_waitcnt vmcnt(0)
    s_branch L_mk_zpi
L_mk_zseti:
    v_mov_b32 v13, 1
    s_mov_b64 exec, 1
    buffer_atomic_add v13, v12, s[36:39], s55 offen sc1
    s_mov_b64 exec, -1
    s_mov_b32 s54, 24576
    s_cmp_eq_u32 s3, 3
    s_cselect_b32 s54, 57344, s54
    s_add_u32 s54, s54, s50
    s_mul_i32 s69, s68, s49
    s_add_u32 s69, s69, s47
    s_add_u32 m0, s54, 0
    s_nop 0
    buffer_load_dwordx4 v8, s[32:35], s69 offen offset:0 lds
    buffer_load_dwordx4 v9, s[32:35], s69 offen offset:1024 lds
    buffer_load_dwordx4 v10, s[32:35], s69 offen offset:2048 lds
    buffer_load_dwordx4 v11, s[32:35], s69 offen offset:3072 lds
    s_add_u32 m0, s54, 4096
    s_add_u32 s69, s69, s53
    buffer_load_dwordx4 v8, s[32:35], s69 offen offset:0 lds
    buffer_load_dwordx4 v9, s[32:35], s69 offen offset:1024 lds
    buffer_load_dwordx4 v10, s[32:35], s69 offen offset:2048 lds
    buffer_load_dwordx4 v11, s[32:35], s69 offen offset:3072 lds
    s_add_u32 s68, s68, 1
    s_and_b32 s68, s68, 7
    s_waitcnt vmcnt(9)
    s_barrier
    s_waitcnt vmcnt(0)
    s_barrier
    s_barrier
    s_barrier
    s_barrier
    s_mov_b32 s12, 0x7f000000
    s_mov_b32 s13, 0x7f000000
    s_mov_b32 s14, 0x7f000000
    s_mov_b32 s15, 0
L_mk_ldone:
    s_bfe_u32 s41, s2, 0x10002
    s_lshl_b32 s41, s41, 2
    s_lshr_b32 s42, s2, 6
    s_add_u32 s41, s41, s42
    s_lshl_b32 s41, s41, 2
    s_and_b32 s42, s2, 3
    s_add_u32 s41, s41, s42
    s_lshl_b32 s59, s41, 17
    s_add_u32 s59, s59, 0x200000
    s_and_b32 s41, s2, 7
    s_lshl_b32 s41, s41, 2
    s_bfe_u32 s42, s2, 0x20003
    s_add_u32 s41, s41, s42
    s_sub_u32 s60, s40, 4
    s_lshl_b32 s61, s41, 8
    s_add_u32 s61, s61, 0xd85000
    s_lshr_b32 s42, s2, 5
    s_lshl_b32 s41, s41, 1
    s_lshl_b32 s42, s42, 1
    s_lshl_b32 s43, s60, 13
    s_lshl_b32 s44, s42, 15
    s_add_u32 s44, s44, s43
    s_add_u32 s44, s44, 0x800000
    s_add_u32 s45, s44, 0x8000
    s_lshl_b32 s46, s41, 15
    s_add_u32 s46, s46, s43
    s_add_u32 s46, s46, 0x600000
    s_add_u32 s47, s46, 0x8000
    s_and_b32 s43, s60, 1
    s_add_u32 s66, s41, s43
    s_lshr_b32 s43, s60, 1
    s_add_u32 s67, s42, s43
    v_and_b32 v84, 31, v1
    v_lshlrev_b32 v84, 10, v84
    v_lshrrev_b32 v85, 5, v1
    v_lshlrev_b32 v85, 3, v85
    v_add_u32 v84, v84, v85
    s_lshl_b32 s54, s66, 15
    s_lshl_b32 s55, s67, 6
    s_add_u32 s54, s54, s55
    s_lshl_b32 s63, s40, 11
    s_lshr_b32 s16, s2, 3
    s_and_b32 s16, s16, 0
    s_lshl_b32 s16, s16, 14
    s_add_u32 s63, s63, s16
    s_add_u32 s63, s63, 8192
    s_mul_i32 s64, s40, 2128
    s_add_u32 s64, s64, 8512
    s_lshl_b32 s65, s40, 2
    s_add_u32 s65, s65, 161728
    s_mov_b32 s28, s4
    s_mov_b32 s29, s5
    s_mov_b32 s30, 0x200000
    s_mov_b32 s31, 0x00020000
    s_mov_b32 s32, s20
    s_mov_b32 s33, s21
    s_mov_b32 s34, 0x400
    s_mov_b32 s35, 0x00020000
    buffer_load_dwordx2 v[68:69], v84, s[28:31], s54 offen offset:0
    buffer_load_dwordx2 v[70:71], v84, s[28:31], s54 offen offset:16
    buffer_load_dwordx2 v[72:73], v84, s[28:31], s54 offen offset:32
    buffer_load_dwordx2 v[74:75], v84, s[28:31], s54 offen offset:48
    buffer_load_dwordx2 v[76:77], v85, s[32:35], s55 offen offset:0
    buffer_load_dwordx2 v[78:79], v85, s[32:35], s55 offen offset:16
    buffer_load_dwordx2 v[80:81], v85, s[32:35], s55 offen offset:32
    buffer_load_dwordx2 v[82:83], v85, s[32:35], s55 offen offset:48
    v_add_u32 v87, 85120, v2
    s_mul_i32 s43, s60, 12768
    s_add_u32 s43, s43, 85120
    v_add_u32 v88, s43, v2
    s_mov_b32 s57, s43
    s_and_b32 s17, s2, 7
    s_lshr_b32 s18, s2, 3
    s_mul_i32 s43, s17, 24
    s_lshl_b32 s48, s17, 5
    s_sub_u32 s48, s48, 32
    s_cmp_lt_u32 s17, 4
    s_cselect_b32 s43, s43, s48
    s_cselect_b32 s19, 24, 32
    s_cmp_ge_u32 s18, s19
    s_cselect_b32 s19, 1, 0
    s_add_u32 s43, s43, s18
    s_mul_i32 s17, s43, 2341
    s_lshr_b32 s17, s17, 16
    s_mul_i32 s18, s17, 28
    s_sub_u32 s18, s43, s18
    s_mov_b32 s43, s18
    s_and_b32 s50, s43, 7
    s_lshr_b32 s48, s2, 5
    v_lshl_add_u32 v4, v1, 3, s48
    s_add_u32 s48, s43, 24
    v_mov_b32 v5, s48
    v_cmp_eq_u32 vcc, 3, v1
    s_nop 1
    v_cndmask_b32 v4, v4, v5, vcc
    v_lshlrev_b32 v4, 8, v4
    s_lshl_b32 s43, s43, 1
    s_and_b32 s52, s60, 1
    s_add_u32 s43, s43, s52
    s_lshl_b32 s52, s43, 15
    s_lshr_b32 s43, s60, 1
    s_lshl_b32 s43, s43, 10
    s_add_u32 s52, s52, s43
    s_add_u32 s52, s52, 0x900000
    s_mul_i32 s62, s60, 6384
    s_add_u32 s62, s62, 136192
    s_mov_b32 s43, 0xd8b000
    s_lshl_b32 s58, s50, 12
    s_add_u32 s53, s52, s58
    v_mov_b32 v91, v4
    s_mov_b32 s51, 0x40000
    s_cmp_lg_u32 s40, 7
    s_cbranch_scc1 L_mk_r2polll
    s_mov_b64 exec, 1
L_mk_r2poll:
    v_mov_b32 v248, 0
    buffer_atomic_add v248, v4, s[36:39], s43 offen sc0 sc1
    s_sub_u32 s51, s51, 1
    s_cmp_eq_u32 s51, 0
    s_waitcnt vmcnt(0)
    s_cbranch_scc1 L_mk_r2pollset
    v_cmp_gt_u32 vcc, 64, v248
    s_nop 4
    s_cbranch_vccz L_mk_r2pollset
    s_sleep 3
    s_branch L_mk_r2poll
L_mk_r2pollset:
    s_mov_b64 exec, -1
    v_mov_b32 v248, 161820
    v_mov_b32 v249, 1
    ds_write_b32 v248, v249
    s_branch L_mk_r2pollwgo
L_mk_r2polll:
    s_mov_b32 s51, 0x400000
    v_mov_b32 v249, 161820
L_mk_r2pollw:
    ds_read_b32 v248, v249
    s_waitcnt lgkmcnt(0)
    s_sub_u32 s51, s51, 1
    v_readfirstlane_b32 s49, v248
    s_cmp_eq_u32 s51, 0
    s_cbranch_scc1 L_mk_r2pollwgo
    s_cmp_ge_u32 s49, 1
    s_cbranch_scc1 L_mk_r2pollwgo
    s_sleep 2
    s_branch L_mk_r2pollw
L_mk_r2pollwgo:
    s_setprio 2
    s_sub_u32 s43, s59, 0x200000
    s_lshr_b32 s43, s43, 18
    s_lshl_b32 s43, s43, 8
    s_add_u32 s43, s43, 0xd80000
    v_mov_b32 v12, 0
    s_mov_b32 s51, 0x400000
    v_mov_b32 v249, 161840
L_mk_cexg:
    ds_read_b32 v248, v249
    s_waitcnt lgkmcnt(0)
    s_sub_u32 s51, s51, 1
    v_readfirstlane_b32 s49, v248
    s_cmp_eq_u32 s51, 0
    s_cbranch_scc1 L_mk_cexggo
    s_cmp_ge_u32 s49, 4
    s_cbranch_scc1 L_mk_cexggo
    s_sleep 1
    s_branch L_mk_cexg
L_mk_cexggo:
    s_mov_b32 s51, 0x40000
    s_cmp_lg_u32 s40, 6
    s_cbranch_scc1 L_mk_qpolll
    s_mov_b64 exec, 1
L_mk_qpoll:
    v_mov_b32 v248, 0
    buffer_atomic_add v248, v12, s[36:39], s43 offen sc0 sc1
    s_sub_u32 s51, s51, 1
    s_cmp_eq_u32 s51, 0
    s_waitcnt vmcnt(0)
    s_cbranch_scc1 L_mk_qpollset
    v_cmp_gt_u32 vcc, 64, v248
    s_nop 4
    s_cbranch_vccz L_mk_qpollset
    s_sleep 3
    s_branch L_mk_qpoll
L_mk_qpollset:
    s_mov_b64 exec, -1
    v_mov_b32 v248, 161812
    v_mov_b32 v249, 1
    ds_write_b32 v248, v249
    s_branch L_mk_qpollwgo
L_mk_qpolll:
    s_mov_b32 s51, 0x400000
    v_mov_b32 v249, 161812
L_mk_qpollw:
    ds_read_b32 v248, v249
    s_waitcnt lgkmcnt(0)
    s_sub_u32 s51, s51, 1
    v_readfirstlane_b32 s49, v248
    s_cmp_eq_u32 s51, 0
    s_cbranch_scc1 L_mk_qpollwgo
    s_cmp_ge_u32 s49, 1
    s_cbranch_scc1 L_mk_qpollwgo
    s_sleep 2
    s_branch L_mk_qpollw
L_mk_qpollwgo:
    s_mov_b32 s51, 0x400000
    v_mov_b32 v249, 161848
L_mk_wqg:
    ds_read_b32 v248, v249
    s_waitcnt lgkmcnt(0)
    s_sub_u32 s51, s51, 1
    v_readfirstlane_b32 s49, v248
    s_cmp_eq_u32 s51, 0
    s_cbranch_scc1 L_mk_wqggo
    s_cmp_ge_u32 s49, 4
    s_cbranch_scc1 L_mk_wqggo
    s_sleep 1
    s_branch L_mk_wqg
L_mk_wqggo:
    s_mov_b32 m0, s64
    s_and_b32 s16, s63, 0x1ffff
    s_add_u32 s16, s16, s59
    s_add_u32 s64, s64, 8512
    buffer_load_dwordx4 v2, s[36:39], s16 offen sc1 lds
    buffer_load_dwordx4 v2, s[36:39], s16 offen offset:1024 sc1 lds
    s_add_u32 s63, s63, 8192
    s_mov_b32 m0, s64
    s_and_b32 s16, s63, 0x1ffff
    s_add_u32 s16, s16, s59
    s_add_u32 s64, s64, 8512
    buffer_load_dwordx4 v2, s[36:39], s16 offen sc1 lds
    buffer_load_dwordx4 v2, s[36:39], s16 offen offset:1024 sc1 lds
    s_add_u32 s63, s63, 8192
    s_mov_b32 m0, s64
    s_and_b32 s16, s63, 0x1ffff
    s_add_u32 s16, s16, s59
    s_add_u32 s64, s64, 8512
    buffer_load_dwordx4 v2, s[36:39], s16 offen sc1 lds
    buffer_load_dwordx4 v2, s[36:39], s16 offen offset:1024 sc1 lds
    s_add_u32 s63, s63, 8192
    s_mov_b32 m0, s64
    s_and_b32 s16, s63, 0x1ffff
    s_add_u32 s16, s16, s59
    s_add_u32 s64, s64, 8512
    buffer_load_dwordx4 v2, s[36:39], s16 offen sc1 lds
    buffer_load_dwordx4 v2, s[36:39], s16 offen offset:1024 sc1 lds
    s_add_u32 s63, s63, 8192
    buffer_load_dwordx4 v[96:99], v2, s[36:39], s44 offen offset:0 sc1
    buffer_load_dwordx4 v[100:103], v2, s[36:39], s45 offen offset:0 sc1
    buffer_load_dwordx4 v[112:115], v2, s[36:39], s44 offen offset:1024 sc1
    buffer_load_dwordx4 v[116:119], v2, s[36:39], s45 offen offset:1024 sc1
    buffer_load_dwordx4 v[128:131], v2, s[36:39], s44 offen offset:2048 sc1
    buffer_load_dwordx4 v[132:135], v2, s[36:39], s45 offen offset:2048 sc1
    buffer_load_dwordx4 v[144:147], v2, s[36:39], s44 offen offset:3072 sc1
    buffer_load_dwordx4 v[148:151], v2, s[36:39], s45 offen offset:3072 sc1
    s_add_u32 s44, s44, 4096
    s_add_u32 s45, s45, 4096
    s_mov_b32 s51, 0x40000
    s_cmp_lg_u32 s40, 7
    s_cbranch_scc1 L_mk_fl
    s_sub_u32 s48, s41, 5
    v_add_u32 v12, s48, v1
    v_and_b32 v12, 63, v12
    v_lshlrev_b32 v12, 8, v12
    v_add_u32 v4, 40960, v4
    v_cmp_gt_u32 vcc, 4, v1
    s_nop 1
    v_cndmask_b32 v12, v12, v4, vcc
    v_cndmask_b32 v13, 16, 64, vcc
    s_mov_b32 s43, 0xd81000
L_mk_fp:
    s_mov_b64 exec, 0xf0
    v_mov_b32 v4, 0
    buffer_atomic_add v4, v12, s[36:39], s43 offen sc0 sc1
    s_sub_u32 s51, s51, 1
    s_waitcnt vmcnt(0)
    v_cmp_gt_u32 vcc, v13, v4
    s_mov_b64 exec, -1
    v_mov_b32 v248, s65
    v_mov_b32 v249, 4
    ds_write_b32 v248, v249
    s_cmp_eq_u32 s51, 0
    s_cbranch_scc1 L_mk_fset
    s_cbranch_vccz L_mk_fset
    s_sleep 3
    s_branch L_mk_fp
L_mk_fset:
    v_mov_b32 v248, 161816
    v_mov_b32 v249, 1
    ds_write_b32 v248, v249
    s_branch L_mk_wfgo
L_mk_fl:
    s_waitcnt vmcnt(8)
    v_mov_b32 v248, s65
    v_mov_b32 v249, 4
    ds_write_b32 v248, v249
    s_mov_b32 s51, 0x400000
    v_mov_b32 v249, 161816
L_mk_wf:
    ds_read_b32 v248, v249
    s_waitcnt lgkmcnt(0)
    s_sub_u32 s51, s51, 1
    v_readfirstlane_b32 s49, v248
    s_cmp_eq_u32 s51, 0
    s_cbranch_scc1 L_mk_wfgo
    s_cmp_ge_u32 s49, 1
    s_cbranch_scc1 L_mk_wfgo
    s_sleep 1
    s_branch L_mk_wf
L_mk_wfgo:
    buffer_load_dwordx4 v[104:107], v2, s[36:39], s46 offen offset:0 sc1
    buffer_load_dwordx4 v[108:111], v2, s[36:39], s47 offen offset:0 sc1
    buffer_load_dwordx4 v[120:123], v2, s[36:39], s46 offen offset:1024 sc1
    buffer_load_dwordx4 v[124:127], v2, s[36:39], s47 offen offset:1024 sc1
    buffer_load_dwordx4 v[136:139], v2, s[36:39], s46 offen offset:2048 sc1
    buffer_load_dwordx4 v[140:143], v2, s[36:39], s47 offen offset:2048 sc1
    buffer_load_dwordx4 v[152:155], v2, s[36:39], s46 offen offset:3072 sc1
    buffer_load_dwordx4 v[156:159], v2, s[36:39], s47 offen offset:3072 sc1
    s_add_u32 s46, s46, 4096
    s_add_u32 s47, s47, 4096
    buffer_load_dwordx4 v[160:163], v2, s[36:39], s44 offen offset:0 sc1
    buffer_load_dwordx4 v[164:167], v2, s[36:39], s45 offen offset:0 sc1
    buffer_load_dwordx4 v[168:171], v2, s[36:39], s46 offen offset:0 sc1
    buffer_load_dwordx4 v[172:175], v2, s[36:39], s47 offen offset:0 sc1
    buffer_load_dwordx4 v[176:179], v2, s[36:39], s44 offen offset:1024 sc1
    buffer_load_dwordx4 v[180:183], v2, s[36:39], s45 offen offset:1024 sc1
    buffer_load_dwordx4 v[184:187], v2, s[36:39], s46 offen offset:1024 sc1
    buffer_load_dwordx4 v[188:191], v2, s[36:39], s47 offen offset:1024 sc1
    buffer_load_dwordx4 v[192:195], v2, s[36:39], s44 offen offset:2048 sc1
    buffer_load_dwordx4 v[196:199], v2, s[36:39], s45 offen offset:2048 sc1
    buffer_load_dwordx4 v[200:203], v2, s[36:39], s46 offen offset:2048 sc1
    buffer_load_dwordx4 v[204:207], v2, s[36:39], s47 offen offset:2048 sc1
    buffer_load_dwordx4 v[208:211], v2, s[36:39], s44 offen offset:3072 sc1
    buffer_load_dwordx4 v[212:215], v2, s[36:39], s45 offen offset:3072 sc1
    buffer_load_dwordx4 v[216:219], v2, s[36:39], s46 offen offset:3072 sc1
    buffer_load_dwordx4 v[220:223], v2, s[36:39], s47 offen offset:3072 sc1
    s_add_u32 s43, s12, 4096
    buffer_store_dwordx4 v[20:23], v2, s[36:39], s12 offen offset:0 sc1
    buffer_store_dwordx4 v[24:27], v2, s[36:39], s12 offen offset:1024 sc1
    buffer_store_dwordx4 v[28:31], v2, s[36:39], s12 offen offset:2048 sc1
    buffer_store_dwordx4 v[32:35], v2, s[36:39], s12 offen offset:3072 sc1
    buffer_store_dwordx4 v[36:39], v2, s[36:39], s43 offen offset:0 sc1
    buffer_store_dwordx4 v[40:43], v2, s[36:39], s43 offen offset:1024 sc1
    buffer_store_dwordx4 v[44:47], v2, s[36:39], s43 offen offset:2048 sc1
    buffer_store_dwordx4 v[48:51], v2, s[36:39], s43 offen offset:3072 sc1
    s_mov_b32 exec_hi, 0
    buffer_store_dwordx2 v[52:53], v2, s[36:39], s13 offen sc1
    s_mov_b32 exec_hi, -1
    s_setprio 2
    s_waitcnt vmcnt(31)
    v_mfma_f32_32x32x16_bf16 v[4:19], v[96:99], v[104:107], 0
    v_mfma_f32_32x32x16_bf16 v[20:35], v[96:99], v[108:111], 0
    v_mfma_f32_32x32x16_bf16 v[36:51], v[100:103], v[104:107], 0
    v_mfma_f32_32x32x16_bf16 v[52:67], v[100:103], v[108:111], 0
    s_waitcnt vmcnt(29)
    v_mfma_f32_32x32x16_bf16 v[4:19], v[112:115], v[120:123], v[4:19]
    v_mfma_f32_32x32x16_bf16 v[20:35], v[112:115], v[124:127], v[20:35]
    v_mfma_f32_32x32x16_bf16 v[36:51], v[116:119], v[120:123], v[36:51]
    v_mfma_f32_32x32x16_bf16 v[52:67], v[116:119], v[124:127], v[52:67]
    s_waitcnt vmcnt(27)
    v_mfma_f32_32x32x16_bf16 v[4:19], v[128:131], v[136:139], v[4:19]
    v_mfma_f32_32x32x16_bf16 v[20:35], v[128:131], v[140:143], v[20:35]
    v_mfma_f32_32x32x16_bf16 v[36:51], v[132:135], v[136:139], v[36:51]
    v_mfma_f32_32x32x16_bf16 v[52:67], v[132:135], v[140:143], v[52:67]
    s_waitcnt vmcnt(25)
    v_mfma_f32_32x32x16_bf16 v[4:19], v[144:147], v[152:155], v[4:19]
    v_mfma_f32_32x32x16_bf16 v[20:35], v[144:147], v[156:159], v[20:35]
    v_mfma_f32_32x32x16_bf16 v[36:51], v[148:151], v[152:155], v[36:51]
    v_mfma_f32_32x32x16_bf16 v[52:67], v[148:151], v[156:159], v[52:67]
    s_waitcnt vmcnt(21)
    v_mfma_f32_32x32x16_bf16 v[4:19], v[160:163], v[168:171], v[4:19]
    v_mfma_f32_32x32x16_bf16 v[20:35], v[160:163], v[172:175], v[20:35]
    v_mfma_f32_32x32x16_bf16 v[36:51], v[164:167], v[168:171], v[36:51]
    v_mfma_f32_32x32x16_bf16 v[52:67], v[164:167], v[172:175], v[52:67]
    s_waitcnt vmcnt(17)
    v_mfma_f32_32x32x16_bf16 v[4:19], v[176:179], v[184:187], v[4:19]
    v_mfma_f32_32x32x16_bf16 v[20:35], v[176:179], v[188:191], v[20:35]
    v_mfma_f32_32x32x16_bf16 v[36:51], v[180:183], v[184:187], v[36:51]
    v_mfma_f32_32x32x16_bf16 v[52:67], v[180:183], v[188:191], v[52:67]
    s_waitcnt vmcnt(13)
    v_mfma_f32_32x32x16_bf16 v[4:19], v[192:195], v[200:203], v[4:19]
    v_mfma_f32_32x32x16_bf16 v[20:35], v[192:195], v[204:207], v[20:35]
    v_mfma_f32_32x32x16_bf16 v[36:51], v[196:199], v[200:203], v[36:51]
    v_mfma_f32_32x32x16_bf16 v[52:67], v[196:199], v[204:207], v[52:67]
    s_waitcnt vmcnt(9)
    v_mfma_f32_32x32x16_bf16 v[4:19], v[208:211], v[216:219], v[4:19]
    v_mfma_f32_32x32x16_bf16 v[20:35], v[208:211], v[220:223], v[20:35]
    v_mfma_f32_32x32x16_bf16 v[36:51], v[212:215], v[216:219], v[36:51]
    v_mfma_f32_32x32x16_bf16 v[52:67], v[212:215], v[220:223], v[52:67]
    s_setprio 2
    s_mov_b32 s51, 0x400000
    v_mov_b32 v249, 161844
L_mk_crl2:
    ds_read_b32 v248, v249
    s_waitcnt lgkmcnt(0)
    s_sub_u32 s51, s51, 1
    v_readfirstlane_b32 s49, v248
    s_cmp_eq_u32 s51, 0
    s_cbranch_scc1 L_mk_crl2go
    s_cmp_ge_u32 s49, 2
    s_cbranch_scc1 L_mk_crl2go
    s_sleep 1
    s_branch L_mk_crl2
L_mk_crl2go:
    s_cmp_eq_u32 s60, 1
    s_cbranch_scc1 L_mk_r1
    s_cmp_eq_u32 s60, 2
    s_cbranch_scc1 L_mk_r2
    s_cmp_eq_u32 s60, 3
    s_cbranch_scc1 L_mk_r3
    ds_write_b128 v87, v[20:23] offset:21280
    ds_write_b128 v87, v[24:27] offset:22304
    ds_write_b128 v87, v[28:31] offset:23408
    ds_write_b128 v87, v[32:35] offset:24432
    ds_write_b128 v87, v[36:39] offset:29792
    ds_write_b128 v87, v[40:43] offset:30816
    ds_write_b128 v87, v[44:47] offset:31920
    ds_write_b128 v87, v[48:51] offset:32944
    ds_write_b128 v87, v[52:55] offset:38304
    ds_write_b128 v87, v[56:59] offset:39328
    ds_write_b128 v87, v[60:63] offset:40432
    ds_write_b128 v87, v[64:67] offset:41456
    s_branch L_mk_rj
L_mk_r1:
    ds_write_b128 v87, v[4:7] offset:0
    ds_write_b128 v87, v[8:11] offset:1024
    ds_write_b128 v87, v[12:15] offset:2128
    ds_write_b128 v87, v[16:19] offset:3152
    ds_write_b128 v87, v[36:39] offset:34048
    ds_write_b128 v87, v[40:43] offset:35072
    ds_write_b128 v87, v[44:47] offset:36176
    ds_write_b128 v87, v[48:51] offset:37200
    ds_write_b128 v87, v[52:55] offset:42560
    ds_write_b128 v87, v[56:59] offset:43584
    ds_write_b128 v87, v[60:63] offset:44688
    ds_write_b128 v87, v[64:67] offset:45712
    v_pk_mov_b32 v[4:5], v[20:21], v[20:21] op_sel:[0,1]
    v_pk_mov_b32 v[6:7], v[22:23], v[22:23] op_sel:[0,1]
    v_pk_mov_b32 v[8:9], v[24:25], v[24:25] op_sel:[0,1]
    v_pk_mov_b32 v[10:11], v[26:27], v[26:27] op_sel:[0,1]
    v_pk_mov_b32 v[12:13], v[28:29], v[28:29] op_sel:[0,1]
    v_pk_mov_b32 v[14:15], v[30:31], v[30:31] op_sel:[0,1]
    v_pk_mov_b32 v[16:17], v[32:33], v[32:33] op_sel:[0,1]
    v_pk_mov_b32 v[18:19], v[34:35], v[34:35] op_sel:[0,1]
    s_branch L_mk_rj
L_mk_r2:
    ds_write_b128 v87, v[4:7] offset:4256
    ds_write_b128 v87, v[8:11] offset:5280
    ds_write_b128 v87, v[12:15] offset:6384
    ds_write_b128 v87, v[16:19] offset:7408
    ds_write_b128 v87, v[20:23] offset:12768
    ds_write_b128 v87, v[24:27] offset:13792
    ds_write_b128 v87, v[28:31] offset:14896
    ds_write_b128 v87, v[32:35] offset:15920
    ds_write_b128 v87, v[52:55] offset:46816
    ds_write_b128 v87, v[56:59] offset:47840
    ds_write_b128 v87, v[60:63] offset:48944
    ds_write_b128 v87, v[64:67] offset:49968
    v_pk_mov_b32 v[4:5], v[36:37], v[36:37] op_sel:[0,1]
    v_pk_mov_b32 v[6:7], v[38:39], v[38:39] op_sel:[0,1]
    v_pk_mov_b32 v[8:9], v[40:41], v[40:41] op_sel:[0,1]
    v_pk_mov_b32 v[10:11], v[42:43], v[42:43] op_sel:[0,1]
    v_pk_mov_b32 v[12:13], v[44:45], v[44:45] op_sel:[0,1]
    v_pk_mov_b32 v[14:15], v[46:47], v[46:47] op_sel:[0,1]
    v_pk_mov_b32 v[16:17], v[48:49], v[48:49] op_sel:[0,1]
    v_pk_mov_b32 v[18:19], v[50:51], v[50:51] op_sel:[0,1]
    s_branch L_mk_rj
L_mk_r3:
    ds_write_b128 v87, v[4:7] offset:8512
    ds_write_b128 v87, v[8:11] offset:9536
    ds_write_b128 v87, v[12:15] offset:10640
    ds_write_b128 v87, v[16:19] offset:11664
    ds_write_b128 v87, v[20:23] offset:17024
    ds_write_b128 v87, v[24:27] offset:18048
    ds_write_b128 v87, v[28:31] offset:19152
    ds_write_b128 v87, v[32:35] offset:20176
    ds_write_b128 v87, v[36:39] offset:25536
    ds_write_b128 v87, v[40:43] offset:26560
    ds_write_b128 v87, v[44:47] offset:27664
    ds_write_b128 v87, v[48:51] offset:28688
    v_pk_mov_b32 v[4:5], v[52:53], v[52:53] op_sel:[0,1]
    v_pk_mov_b32 v[6:7], v[54:55], v[54:55] op_sel:[0,1]
    v_pk_mov_b32 v[8:9], v[56:57], v[56:57] op_sel:[0,1]
    v_pk_mov_b32 v[10:11], v[58:59], v[58:59] op_sel:[0,1]
    v_pk_mov_b32 v[12:13], v[60:61], v[60:61] op_sel:[0,1]
    v_pk_mov_b32 v[14:15], v[62:63], v[62:63] op_sel:[0,1]
    v_pk_mov_b32 v[16:17], v[64:65], v[64:65] op_sel:[0,1]
    v_pk_mov_b32 v[18:19], v[66:67], v[66:67] op_sel:[0,1]
L_mk_rj:
    s_waitcnt lgkmcnt(0)
    v_mov_b32 v248, 161792
    v_mov_b32 v249, 1
    s_mov_b64 exec, 1
    ds_add_u32 v248, v249
    s_mov_b64 exec, -1
    s_waitcnt vmcnt(0)
    v_mov_b32 v250, s15
    v_mov_b32 v251, 0
    s_mov_b64 exec, 1
    buffer_atomic_add v250, v251, s[36:39], s14 offen sc1
    s_mov_b64 exec, -1
    v_lshlrev_b32 v96, 16, v68
    v_and_b32 v97, 0xffff0000, v68
    v_lshlrev_b32 v98, 16, v69
    v_and_b32 v99, 0xffff0000, v69
    v_lshlrev_b32 v100, 16, v70
    v_and_b32 v101, 0xffff0000, v70
    v_lshlrev_b32 v102, 16, v71
    v_and_b32 v103, 0xffff0000, v71
    v_lshlrev_b32 v104, 16, v72
    v_and_b32 v105, 0xffff0000, v72
    v_lshlrev_b32 v106, 16, v73
    v_and_b32 v107, 0xffff0000, v73
    v_lshlrev_b32 v108, 16, v74
    v_and_b32 v109, 0xffff0000, v74
    v_lshlrev_b32 v110, 16, v75
    v_and_b32 v111, 0xffff0000, v75
    v_pk_add_f32 v[4:5], v[4:5], v[96:97]
    v_pk_add_f32 v[6:7], v[6:7], v[98:99]
    v_pk_add_f32 v[8:9], v[8:9], v[100:101]
    v_pk_add_f32 v[10:11], v[10:11], v[102:103]
    v_pk_add_f32 v[12:13], v[12:13], v[104:105]
    v_pk_add_f32 v[14:15], v[14:15], v[106:107]
    v_pk_add_f32 v[16:17], v[16:17], v[108:109]
    v_pk_add_f32 v[18:19], v[18:19], v[110:111]
    v_mov_b32 v112, 0
    v_mov_b32 v113, 0
    v_mov_b32 v114, 0
    v_mov_b32 v115, 0x3f803f80
    v_dot2_f32_bf16 v114, v68, v76, v114
    v_dot2_f32_bf16 v114, v69, v77, v114
    v_dot2_f32_bf16 v114, v70, v78, v114
    v_dot2_f32_bf16 v114, v71, v79, v114
    v_dot2_f32_bf16 v114, v72, v80, v114
    v_dot2_f32_bf16 v114, v73, v81, v114
    v_dot2_f32_bf16 v114, v74, v82, v114
    v_dot2_f32_bf16 v114, v75, v83, v114
    s_lshl_b32 s46, s66, 15
    s_lshl_b32 s47, s67, 11
    s_add_u32 s46, s46, s47
    s_add_u32 s68, s46, 0xe00000
    s_lshl_b32 s46, s66, 13
    s_lshl_b32 s47, s67, 9
    s_add_u32 s46, s46, s47
    s_add_u32 s46, s46, 0x1000000
    s_mov_b32 s51, 0x400000
    v_mov_b32 v249, 161792
L_mk_c2:
    ds_read_b32 v248, v249
    s_waitcnt lgkmcnt(0)
    s_sub_u32 s51, s51, 1
    v_readfirstlane_b32 s49, v248
    s_cmp_eq_u32 s51, 0
    s_cbranch_scc1 L_mk_c2go
    s_cmp_ge_u32 s49, 4
    s_cbranch_scc1 L_mk_c2go
    s_sleep 1
    s_branch L_mk_c2
L_mk_c2go:
    ds_read_b128 v[20:23], v88 offset:0
    ds_read_b128 v[24:27], v88 offset:1024
    ds_read_b128 v[28:31], v88 offset:2128
    ds_read_b128 v[32:35], v88 offset:3152
    ds_read_b128 v[36:39], v88 offset:4256
    ds_read_b128 v[40:43], v88 offset:5280
    ds_read_b128 v[44:47], v88 offset:6384
    ds_read_b128 v[48:51], v88 offset:7408
    ds_read_b128 v[52:55], v88 offset:8512
    ds_read_b128 v[56:59], v88 offset:9536
    ds_read_b128 v[60:63], v88 offset:10640
    ds_read_b128 v[64:67], v88 offset:11664
    s_waitcnt lgkmcnt(4)
    v_pk_add_f32 v[20:21], v[20:21], v[36:37]
    v_pk_add_f32 v[22:23], v[22:23], v[38:39]
    v_pk_add_f32 v[24:25], v[24:25], v[40:41]
    v_pk_add_f32 v[26:27], v[26:27], v[42:43]
    v_pk_add_f32 v[28:29], v[28:29], v[44:45]
    v_pk_add_f32 v[30:31], v[30:31], v[46:47]
    v_pk_add_f32 v[32:33], v[32:33], v[48:49]
    v_pk_add_f32 v[34:35], v[34:35], v[50:51]
    v_pk_add_f32 v[4:5], v[4:5], v[20:21]
    v_pk_add_f32 v[6:7], v[6:7], v[22:23]
    v_pk_add_f32 v[8:9], v[8:9], v[24:25]
    v_pk_add_f32 v[10:11], v[10:11], v[26:27]
    v_pk_add_f32 v[12:13], v[12:13], v[28:29]
    v_pk_add_f32 v[14:15], v[14:15], v[30:31]
    v_pk_add_f32 v[16:17], v[16:17], v[32:33]
    v_pk_add_f32 v[18:19], v[18:19], v[34:35]
    s_waitcnt lgkmcnt(0)
    v_pk_add_f32 v[4:5], v[4:5], v[52:53]
    v_pk_add_f32 v[6:7], v[6:7], v[54:55]
    v_pk_add_f32 v[8:9], v[8:9], v[56:57]
    v_pk_add_f32 v[10:11], v[10:11], v[58:59]
    v_pk_add_f32 v[12:13], v[12:13], v[60:61]
    v_pk_add_f32 v[14:15], v[14:15], v[62:63]
    v_pk_add_f32 v[16:17], v[16:17], v[64:65]
    v_pk_add_f32 v[18:19], v[18:19], v[66:67]
    v_cvt_pk_bf16_f32 v4, v4, v5
    v_cvt_pk_bf16_f32 v5, v6, v7
    v_cvt_pk_bf16_f32 v6, v8, v9
    v_cvt_pk_bf16_f32 v7, v10, v11
    v_cvt_pk_bf16_f32 v8, v12, v13
    v_cvt_pk_bf16_f32 v9, v14, v15
    v_cvt_pk_bf16_f32 v10, v16, v17
    v_cvt_pk_bf16_f32 v11, v18, v19
    buffer_store_dwordx4 v[4:7], v2, s[36:39], s68 offen sc1
    buffer_store_dwordx4 v[8:11], v2, s[36:39], s68 offen offset:1024 sc1
    v_dot2_f32_bf16 v112, v4, v115, v112
    v_dot2_f32_bf16 v113, v4, v4, v113
    v_dot2_f32_bf16 v112, v5, v115, v112
    v_dot2_f32_bf16 v113, v5, v5, v113
    v_dot2_f32_bf16 v112, v6, v115, v112
    v_dot2_f32_bf16 v113, v6, v6, v113
    v_dot2_f32_bf16 v112, v7, v115, v112
    v_dot2_f32_bf16 v113, v7, v7, v113
    v_dot2_f32_bf16 v112, v8, v115, v112
    v_dot2_f32_bf16 v113, v8, v8, v113
    v_dot2_f32_bf16 v112, v9, v115, v112
    v_dot2_f32_bf16 v113, v9, v9, v113
    v_dot2_f32_bf16 v112, v10, v115, v112
    v_dot2_f32_bf16 v113, v10, v10, v113
    v_dot2_f32_bf16 v112, v11, v115, v112
    v_dot2_f32_bf16 v113, v11, v11, v113
    s_nop 1
    v_mov_b32 v116, v112
    v_mov_b32 v117, v113
    v_mov_b32 v118, v114
    v_permlane32_swap_b32 v116, v112
    v_permlane32_swap_b32 v117, v113
    v_permlane32_swap_b32 v118, v114
    s_nop 1
    v_add_f32 v116, v116, v112
    v_add_f32 v117, v117, v113
    v_add_f32 v118, v118, v114
    v_mov_b32 v119, 0
    s_mov_b32 exec_hi, 0
    buffer_store_dwordx4 v[116:119], v2, s[36:39], s46 offen sc1
    s_mov_b32 exec_hi, -1
    s_mov_b32 m0, s64
    s_and_b32 s16, s63, 0x1ffff
    s_add_u32 s16, s16, s59
    s_add_u32 s64, s64, 8512
    buffer_load_dwordx4 v2, s[36:39], s16 offen sc1 lds
    buffer_load_dwordx4 v2, s[36:39], s16 offen offset:1024 sc1 lds
    s_add_u32 s63, s63, 8192
    s_mov_b32 m0, s64
    s_and_b32 s16, s63, 0x1ffff
    s_add_u32 s16, s16, s59
    s_add_u32 s64, s64, 8512
    buffer_load_dwordx4 v2, s[36:39], s16 offen sc1 lds
    buffer_load_dwordx4 v2, s[36:39], s16 offen offset:1024 sc1 lds
    s_add_u32 s63, s63, 8192
    s_mov_b32 m0, s64
    s_and_b32 s16, s63, 0x1ffff
    s_add_u32 s16, s16, s59
    s_add_u32 s64, s64, 8512
    buffer_load_dwordx4 v2, s[36:39], s16 offen sc1 lds
    buffer_load_dwordx4 v2, s[36:39], s16 offen offset:1024 sc1 lds
    s_add_u32 s63, s63, 8192
    s_mov_b32 m0, s64
    s_and_b32 s16, s63, 0x1ffff
    s_add_u32 s16, s16, s59
    s_add_u32 s64, s64, 8512
    buffer_load_dwordx4 v2, s[36:39], s16 offen sc1 lds
    buffer_load_dwordx4 v2, s[36:39], s16 offen offset:1024 sc1 lds
    s_add_u32 s63, s63, 8192
    v_mov_b32 v250, 1
    v_mov_b32 v251, 0
    s_waitcnt vmcnt(8)
    s_mov_b64 exec, 1
    buffer_atomic_add v250, v251, s[36:39], s61 offen sc1
    s_mov_b64 exec, -1
    s_mov_b32 s43, 0xd8b000
    s_mov_b32 s51, 0x40000
    s_cmp_lg_u32 s40, 6
    s_cbranch_scc1 L_mk_rpolll
    s_mov_b64 exec, 15
L_mk_rpoll:
    v_mov_b32 v248, 0
    buffer_atomic_add v248, v91, s[36:39], s43 offen sc0 sc1
    s_sub_u32 s51, s51, 1
    s_cmp_eq_u32 s51, 0
    s_waitcnt vmcnt(0)
    s_cbranch_scc1 L_mk_rpollset
    v_cmp_gt_u32 vcc, 56, v248
    s_nop 4
    s_cbranch_vccz L_mk_rpollset
    s_sleep 3
    s_branch L_mk_rpoll
L_mk_rpollset:
    s_mov_b64 exec, -1
    v_mov_b32 v248, 161836
    v_mov_b32 v249, 1
    ds_write_b32 v248, v249
    s_branch L_mk_rpollwgo
L_mk_rpolll:
    s_mov_b32 s51, 0x400000
    v_mov_b32 v249, 161836
L_mk_rpollw:
    ds_read_b32 v248, v249
    s_waitcnt lgkmcnt(0)
    s_sub_u32 s51, s51, 1
    v_readfirstlane_b32 s49, v248
    s_cmp_eq_u32 s51, 0
    s_cbranch_scc1 L_mk_rpollwgo
    s_cmp_ge_u32 s49, 1
    s_cbranch_scc1 L_mk_rpollwgo
    s_sleep 2
    s_branch L_mk_rpollw
L_mk_rpollwgo:
    s_add_u32 m0, s62, 0
    s_nop 0
    buffer_load_dwordx4 v2, s[36:39], s53 offen sc1 lds
    s_add_u32 m0, s62, 1024
    s_add_u32 s53, s53, 2048
    buffer_load_dwordx4 v2, s[36:39], s53 offen sc1 lds
    s_add_u32 s58, s58, 4096
    s_cmp_eq_u32 s58, 32768
    s_cselect_b32 s58, 0, s58
    s_add_u32 s53, s52, s58
    s_add_u32 m0, s62, 2128
    s_nop 0
    buffer_load_dwordx4 v2, s[36:39], s53 offen sc1 lds
    s_add_u32 m0, s62, 3152
    s_add_u32 s53, s53, 2048
    buffer_load_dwordx4 v2, s[36:39], s53 offen sc1 lds
    s_add_u32 s58, s58, 4096
    s_cmp_eq_u32 s58, 32768
    s_cselect_b32 s58, 0, s58
    s_add_u32 s53, s52, s58
    s_add_u32 m0, s62, 4256
    s_nop 0
    buffer_load_dwordx4 v2, s[36:39], s53 offen sc1 lds
    s_add_u32 m0, s62, 5280
    s_add_u32 s53, s53, 2048
    buffer_load_dwordx4 v2, s[36:39], s53 offen sc1 lds
    s_add_u32 s58, s58, 4096
    s_cmp_eq_u32 s58, 32768
    s_cselect_b32 s58, 0, s58
    s_add_u32 s53, s52, s58
    s_waitcnt vmcnt(7)
    v_mov_b32 v248, s65
    v_mov_b32 v249, 5
    ds_write_b32 v248, v249
    s_mul_i32 s64, s60, 2128
    s_lshl_b32 s41, s17, 3
    s_lshl_b32 s43, s60, 1
    s_add_u32 s41, s41, s43
    s_lshl_b32 s42, s18, 1
    s_cmp_eq_u32 s19, 1
    s_cbranch_scc1 L_mk_now3
    s_mov_b32 s55, s50
    s_lshl_b32 s46, s41, 15
    s_add_u32 s46, s46, 0xe00000
    s_add_u32 s47, s46, 0x8000
    s_lshl_b32 s44, s41, 13
    s_add_u32 s44, s44, 0x1000000
    s_add_u32 s45, s44, 0x2000
    s_lshl_b32 s50, s42, 10
    s_add_u32 s50, s50, 0xd00000
    s_lshl_b32 s61, s41, 7
    s_add_u32 s61, s61, 0xd85000
    s_mul_i32 s48, s41, 114688
    s_lshl_b32 s43, s42, 11
    s_add_u32 s48, s48, s43
    s_add_u32 s48, s48, 0x1100000
    s_lshl_b32 s69, s41, 7
    s_add_u32 s69, s69, 0xd87000
    v_and_b32 v84, 31, v1
    v_lshlrev_b32 v84, 4, v84
    v_lshrrev_b32 v86, 5, v1
    v_lshl_add_u32 v84, v86, 12, v84
    v_lshlrev_b32 v85, 8, v1
    v_add_u32 v88, 136192, v2
    s_lshl_b32 s3, s55, 12
    s_add_u32 s54, s46, s3
    s_add_u32 s56, s47, s3
    s_mov_b32 s51, 0x40000
    s_cmp_lg_u32 s40, 4
    s_cbranch_scc1 L_mk_xpolll
    s_mov_b64 exec, 15
L_mk_xpoll:
    v_mov_b32 v248, 0
    buffer_atomic_add v248, v85, s[36:39], s61 offen sc0 sc1
    s_sub_u32 s51, s51, 1
    s_cmp_eq_u32 s51, 0
    s_waitcnt vmcnt(0)
    s_cbranch_scc1 L_mk_xpollset
    v_cmp_gt_u32 vcc, 32, v248
    s_nop 4
    s_cbranch_vccz L_mk_xpollset
    s_sleep 3
    s_branch L_mk_xpoll
L_mk_xpollset:
    s_mov_b64 exec, -1
    v_mov_b32 v248, 161776
    v_mov_b32 v249, 1
    ds_write_b32 v248, v249
    s_branch L_mk_xpollwgo
L_mk_xpolll:
    s_mov_b32 s51, 0x400000
    v_mov_b32 v249, 161776
L_mk_xpollw:
    ds_read_b32 v248, v249
    s_waitcnt lgkmcnt(0)
    s_sub_u32 s51, s51, 1
    v_readfirstlane_b32 s49, v248
    s_cmp_eq_u32 s51, 0
    s_cbranch_scc1 L_mk_xpollwgo
    s_cmp_ge_u32 s49, 1
    s_cbranch_scc1 L_mk_xpollwgo
    s_sleep 2
    s_branch L_mk_xpollw
L_mk_xpollwgo:
    buffer_load_dwordx4 v[96:99], v2, s[36:39], s54 offen offset:0 sc1
    buffer_load_dwordx4 v[100:103], v2, s[36:39], s56 offen offset:0 sc1
    buffer_load_dwordx4 v[104:107], v2, s[36:39], s54 offen offset:1024 sc1
    buffer_load_dwordx4 v[108:111], v2, s[36:39], s56 offen offset:1024 sc1
    s_waitcnt vmcnt(4)
    v_mov_b32 v248, 161796
    v_mov_b32 v249, 1
    s_mov_b64 exec, 1
    ds_add_u32 v248, v249
    s_mov_b64 exec, -1
    buffer_load_dwordx4 v[112:115], v2, s[36:39], s54 offen offset:2048 sc1
    buffer_load_dwordx4 v[116:119], v2, s[36:39], s56 offen offset:2048 sc1
    buffer_load_dwordx4 v[120:123], v2, s[36:39], s54 offen offset:3072 sc1
    buffer_load_dwordx4 v[124:127], v2, s[36:39], s56 offen offset:3072 sc1
    s_add_u32 s3, s3, 4096
    s_cmp_eq_u32 s3, 32768
    s_cselect_b32 s3, 0, s3
    s_add_u32 s54, s46, s3
    s_add_u32 s56, s47, s3
    buffer_load_dwordx4 v[128:131], v2, s[36:39], s54 offen offset:0 sc1
    buffer_load_dwordx4 v[132:135], v2, s[36:39], s56 offen offset:0 sc1
    buffer_load_dwordx4 v[136:139], v2, s[36:39], s54 offen offset:1024 sc1
    buffer_load_dwordx4 v[140:143], v2, s[36:39], s56 offen offset:1024 sc1
    s_mov_b32 s51, 0x400000
    v_mov_b32 v249, 161796
L_mk_c3a:
    ds_read_b32 v248, v249
    s_waitcnt lgkmcnt(0)
    s_sub_u32 s51, s51, 1
    v_readfirstlane_b32 s49, v248
    s_cmp_eq_u32 s51, 0
    s_cbranch_scc1 L_mk_c3ago
    s_cmp_ge_u32 s49, 4
    s_cbranch_scc1 L_mk_c3ago
    s_sleep 1
    s_branch L_mk_c3a
L_mk_c3ago:
    s_setprio 0
    ds_read_b128 v[224:227], v88 offset:0
    ds_read_b128 v[228:231], v88 offset:6384
    s_waitcnt vmcnt(10) lgkmcnt(0)
    v_mfma_f32_32x32x16_bf16 v[4:19], v[224:227], v[96:99], 0
    ds_read_b128 v[232:235], v88 offset:12768
    ds_read_b128 v[236:239], v88 offset:19152
    buffer_load_dwordx4 v[144:147], v2, s[36:39], s54 offen offset:2048 sc1
    buffer_load_dwordx4 v[148:151], v2, s[36:39], s56 offen offset:2048 sc1
    s_add_u32 m0, s57, 0
    v_mfma_f32_32x32x16_bf16 v[20:35], v[224:227], v[100:103], 0
    buffer_load_dwordx4 v2, s[36:39], s53 offen sc1 lds
    s_add_u32 m0, s57, 1024
    s_add_u32 s53, s53, 2048
    buffer_load_dwordx4 v2, s[36:39], s53 offen sc1 lds
    s_add_u32 s58, s58, 4096
    v_mfma_f32_32x32x16_bf16 v[36:51], v[228:231], v[96:99], 0
    s_cmp_eq_u32 s58, 32768
    s_cselect_b32 s58, 0, s58
    s_add_u32 s53, s52, s58
    v_mfma_f32_32x32x16_bf16 v[52:67], v[228:231], v[100:103], 0
    s_waitcnt vmcnt(12) lgkmcnt(0)
    v_mfma_f32_32x32x16_bf16 v[4:19], v[232:235], v[104:107], v[4:19]
    ds_read_b128 v[224:227], v88 offset:1024
    ds_read_b128 v[228:231], v88 offset:7408
    buffer_load_dwordx4 v[152:155], v2, s[36:39], s54 offen offset:3072 sc1
    buffer_load_dwordx4 v[156:159], v2, s[36:39], s56 offen offset:3072 sc1
    s_add_u32 s3, s3, 4096
    s_cmp_eq_u32 s3, 32768
    v_mfma_f32_32x32x16_bf16 v[20:35], v[232:235], v[108:111], v[20:35]
    s_cselect_b32 s3, 0, s3
    s_add_u32 s54, s46, s3
    s_add_u32 s56, s47, s3
    s_add_u32 m0, s57, 2128
    s_nop 0
    buffer_load_dwordx4 v2, s[36:39], s53 offen sc1 lds
    s_add_u32 m0, s57, 3152
    v_mfma_f32_32x32x16_bf16 v[36:51], v[236:239], v[104:107], v[36:51]
    s_add_u32 s53, s53, 2048
    buffer_load_dwordx4 v2, s[36:39], s53 offen sc1 lds
    s_add_u32 s58, s58, 4096
    s_cmp_eq_u32 s58, 32768
    s_cselect_b32 s58, 0, s58
    s_add_u32 s53, s52, s58
    v_mfma_f32_32x32x16_bf16 v[52:67], v[236:239], v[108:111], v[52:67]
    s_waitcnt vmcnt(14) lgkmcnt(0)
    v_mfma_f32_32x32x16_bf16 v[4:19], v[224:227], v[112:115], v[4:19]
    ds_read_b128 v[232:235], v88 offset:13792
    ds_read_b128 v[236:239], v88 offset:20176
    buffer_load_dwordx4 v[160:163], v2, s[36:39], s54 offen offset:0 sc1
    buffer_load_dwordx4 v[164:167], v2, s[36:39], s56 offen offset:0 sc1
    s_add_u32 m0, s57, 4256
    v_mfma_f32_32x32x16_bf16 v[20:35], v[224:227], v[116:119], v[20:35]
    buffer_load_dwordx4 v2, s[36:39], s53 offen sc1 lds
    s_add_u32 m0, s57, 5280
    s_add_u32 s53, s53, 2048
    buffer_load_dwordx4 v2, s[36:39], s53 offen sc1 lds
    s_add_u32 s58, s58, 4096
    v_mfma_f32_32x32x16_bf16 v[36:51], v[228:231], v[112:115], v[36:51]
    s_cmp_eq_u32 s58, 32768
    s_cselect_b32 s58, 0, s58
    s_add_u32 s53, s52, s58
    v_mfma_f32_32x32x16_bf16 v[52:67], v[228:231], v[116:119], v[52:67]
    s_waitcnt vmcnt(16) lgkmcnt(0)
    v_mfma_f32_32x32x16_bf16 v[4:19], v[232:235], v[120:123], v[4:19]
    ds_read_b128 v[224:227], v88 offset:2128
    ds_read_b128 v[228:231], v88 offset:8512
    buffer_load_dwordx4 v[168:171], v2, s[36:39], s54 offen offset:1024 sc1
    buffer_load_dwordx4 v[172:175], v2, s[36:39], s56 offen offset:1024 sc1
    s_add_u32 m0, s57, 6384
    v_mfma_f32_32x32x16_bf16 v[20:35], v[232:235], v[124:127], v[20:35]
    buffer_load_dwordx4 v2, s[36:39], s53 offen sc1 lds
    s_add_u32 m0, s57, 7408
    s_add_u32 s53, s53, 2048
    buffer_load_dwordx4 v2, s[36:39], s53 offen sc1 lds
    s_add_u32 s58, s58, 4096
    v_mfma_f32_32x32x16_bf16 v[36:51], v[236:239], v[120:123], v[36:51]
    s_cmp_eq_u32 s58, 32768
    s_cselect_b32 s58, 0, s58
    s_add_u32 s53, s52, s58
    v_mfma_f32_32x32x16_bf16 v[52:67], v[236:239], v[124:127], v[52:67]
    s_waitcnt vmcnt(18) lgkmcnt(0)
    v_mfma_f32_32x32x16_bf16 v[4:19], v[224:227], v[128:131], v[4:19]
    ds_read_b128 v[232:235], v88 offset:14896
    ds_read_b128 v[236:239], v88 offset:21280
    buffer_load_dwordx4 v[176:179], v2, s[36:39], s54 offen offset:2048 sc1
    v_mfma_f32_32x32x16_bf16 v[20:35], v[224:227], v[132:135], v[20:35]
    buffer_load_dwordx4 v[180:183], v2, s[36:39], s56 offen offset:2048 sc1
    s_add_u32 m0, s57, 8512
    s_nop 0
    buffer_load_dwordx4 v2, s[36:39], s53 offen sc1 lds
    v_mfma_f32_32x32x16_bf16 v[36:51], v[228:231], v[128:131], v[36:51]
    s_add_u32 m0, s57, 9536
    s_add_u32 s53, s53, 2048
    buffer_load_dwordx4 v2, s[36:39], s53 offen sc1 lds
    v_mfma_f32_32x32x16_bf16 v[52:67], v[228:231], v[132:135], v[52:67]
    s_waitcnt vmcnt(20) lgkmcnt(0)
    v_mfma_f32_32x32x16_bf16 v[4:19], v[232:235], v[136:139], v[4:19]
    ds_read_b128 v[224:227], v88 offset:3152
    ds_read_b128 v[228:231], v88 offset:9536
    buffer_load_dwordx4 v[184:187], v2, s[36:39], s54 offen offset:3072 sc1
    v_mfma_f32_32x32x16_bf16 v[20:35], v[232:235], v[140:143], v[20:35]
    buffer_load_dwordx4 v[188:191], v2, s[36:39], s56 offen offset:3072 sc1
    s_add_u32 s3, s3, 4096
    s_cmp_eq_u32 s3, 32768
    v_mfma_f32_32x32x16_bf16 v[36:51], v[236:239], v[136:139], v[36:51]
    s_cselect_b32 s3, 0, s3
    s_add_u32 s54, s46, s3
    s_add_u32 s56, s47, s3
    v_mfma_f32_32x32x16_bf16 v[52:67], v[236:239], v[140:143], v[52:67]
    s_waitcnt vmcnt(20) lgkmcnt(0)
    v_mfma_f32_32x32x16_bf16 v[4:19], v[224:227], v[144:147], v[4:19]
    ds_read_b128 v[232:235], v88 offset:15920
    ds_read_b128 v[236:239], v88 offset:22304
    buffer_load_dwordx4 v[192:195], v2, s[36:39], s54 offen offset:0 sc1
    buffer_load_dwordx4 v[196:199], v2, s[36:39], s56 offen offset:0 sc1
    v_mfma_f32_32x32x16_bf16 v[20:35], v[224:227], v[148:151], v[20:35]
    buffer_load_dwordx2 v[68:69], v84, s[36:39], s44 offen offset:0 sc1
    buffer_load_dwordx2 v[70:71], v84, s[36:39], s44 offen offset:512 sc1
    buffer_load_dwordx2 v[72:73], v84, s[36:39], s44 offen offset:1024 sc1
    buffer_load_dwordx2 v[74:75], v84, s[36:39], s44 offen offset:1536 sc1
    v_mfma_f32_32x32x16_bf16 v[36:51], v[228:231], v[144:147], v[36:51]
    buffer_load_dwordx2 v[76:77], v84, s[36:39], s44 offen offset:2048 sc1
    buffer_load_dwordx2 v[78:79], v84, s[36:39], s44 offen offset:2560 sc1
    buffer_load_dwordx2 v[80:81], v84, s[36:39], s44 offen offset:3072 sc1
    buffer_load_dwordx2 v[82:83], v84, s[36:39], s44 offen offset:3584 sc1
    v_mfma_f32_32x32x16_bf16 v[52:67], v[228:231], v[148:151], v[52:67]
    s_setprio 2
    s_mov_b32 s51, 0x400000
    v_mov_b32 v252, 161760
L_mk_pw:
    ds_read_b128 v[248:251], v252
    s_waitcnt lgkmcnt(0)
    v_min3_u32 v248, v248, v249, v250
    v_min_u32 v248, v248, v251
    s_sub_u32 s51, s51, 1
    v_readfirstlane_b32 s49, v248
    s_cmp_eq_u32 s51, 0
    s_cbranch_scc1 L_mk_pwgo
    s_cmp_ge_u32 s49, 16
    s_cbranch_scc1 L_mk_pwgo
    s_sleep 2
    s_branch L_mk_pw
L_mk_pwgo:
    s_setprio 0
    s_waitcnt vmcnt(26) lgkmcnt(0)
    v_mfma_f32_32x32x16_bf16 v[4:19], v[232:235], v[152:155], v[4:19]
    ds_read_b128 v[224:227], v88 offset:4256
    ds_read_b128 v[228:231], v88 offset:10640
    buffer_load_dwordx4 v[200:203], v2, s[36:39], s54 offen offset:1024 sc1
    buffer_load_dwordx4 v[204:207], v2, s[36:39], s56 offen offset:1024 sc1
    v_mfma_f32_32x32x16_bf16 v[20:35], v[232:235], v[156:159], v[20:35]
    s_mov_b32 m0, s64
    s_and_b32 s16, s63, 0x1ffff
    s_add_u32 s16, s16, s59
    s_add_u32 s64, s64, 8512
    v_mfma_f32_32x32x16_bf16 v[36:51], v[236:239], v[152:155], v[36:51]
    buffer_load_dwordx4 v2, s[36:39], s16 offen sc1 lds
    buffer_load_dwordx4 v2, s[36:39], s16 offen offset:1024 sc1 lds
    s_add_u32 s63, s63, 8192
    v_mfma_f32_32x32x16_bf16 v[52:67], v[236:239], v[156:159], v[52:67]
    s_waitcnt vmcnt(26) lgkmcnt(0)
    v_mfma_f32_32x32x16_bf16 v[4:19], v[224:227], v[160:163], v[4:19]
    ds_read_b128 v[232:235], v88 offset:17024
    ds_read_b128 v[236:239], v88 offset:23408
    buffer_load_dwordx4 v[208:211], v2, s[36:39], s54 offen offset:2048 sc1
    buffer_load_dwordx4 v[212:215], v2, s[36:39], s56 offen offset:2048 sc1
    v_mfma_f32_32x32x16_bf16 v[20:35], v[224:227], v[164:167], v[20:35]
    s_mov_b32 m0, s64
    s_and_b32 s16, s63, 0x1ffff
    s_add_u32 s16, s16, s59
    s_add_u32 s64, s64, 8512
    v_mfma_f32_32x32x16_bf16 v[36:51], v[228:231], v[160:163], v[36:51]
    buffer_load_dwordx4 v2, s[36:39], s16 offen sc1 lds
    buffer_load_dwordx4 v2, s[36:39], s16 offen offset:1024 sc1 lds
    s_add_u32 s63, s63, 8192
    v_mfma_f32_32x32x16_bf16 v[52:67], v[228:231], v[164:167], v[52:67]
    s_waitcnt vmcnt(26) lgkmcnt(0)
    v_mfma_f32_32x32x16_bf16 v[4:19], v[232:235], v[168:171], v[4:19]
    ds_read_b128 v[224:227], v88 offset:5280
    ds_read_b128 v[228:231], v88 offset:11664
    buffer_load_dwordx4 v[216:219], v2, s[36:39], s54 offen offset:3072 sc1
    buffer_load_dwordx4 v[220:223], v2, s[36:39], s56 offen offset:3072 sc1
    s_add_u32 s3, s3, 4096
    s_cmp_eq_u32 s3, 32768
    v_mfma_f32_32x32x16_bf16 v[20:35], v[232:235], v[172:175], v[20:35]
    s_cselect_b32 s3, 0, s3
    s_add_u32 s54, s46, s3
    s_add_u32 s56, s47, s3
    s_mov_b32 m0, s64
    s_and_b32 s16, s63, 0x1ffff
    s_add_u32 s16, s16, s59
    v_mfma_f32_32x32x16_bf16 v[36:51], v[236:239], v[168:171], v[36:51]
    s_add_u32 s64, s64, 8512
    buffer_load_dwordx4 v2, s[36:39], s16 offen sc1 lds
    buffer_load_dwordx4 v2, s[36:39], s16 offen offset:1024 sc1 lds
    s_add_u32 s63, s63, 8192
    v_mfma_f32_32x32x16_bf16 v[52:67], v[236:239], v[172:175], v[52:67]
    s_waitcnt vmcnt(24)
    s_setprio 2
    v_mov_b32 v248, 161800
    v_mov_b32 v249, 1
    s_mov_b64 exec, 1
    ds_add_u32 v248, v249
    s_mov_b64 exec, -1
    s_setprio 0
    s_waitcnt vmcnt(24) lgkmcnt(0)
    v_mfma_f32_32x32x16_bf16 v[4:19], v[224:227], v[176:179], v[4:19]
    ds_read_b128 v[232:235], v88 offset:18048
    ds_read_b128 v[236:239], v88 offset:24432
    buffer_load_dwordx4 v[96:99], v2, s[36:39], s54 offen offset:0 sc1
    buffer_load_dwordx4 v[100:103], v2, s[36:39], s56 offen offset:0 sc1
    v_mfma_f32_32x32x16_bf16 v[20:35], v[224:227], v[180:183], v[20:35]
    s_mov_b32 m0, s64
    s_and_b32 s16, s63, 0x1ffff
    s_add_u32 s16, s16, s59
    s_add_u32 s64, s64, 8512
    v_mfma_f32_32x32x16_bf16 v[36:51], v[228:231], v[176:179], v[36:51]
    buffer_load_dwordx4 v2, s[36:39], s16 offen sc1 lds
    buffer_load_dwordx4 v2, s[36:39], s16 offen offset:1024 sc1 lds
    s_add_u32 s63, s63, 8192
    v_mfma_f32_32x32x16_bf16 v[52:67], v[228:231], v[180:183], v[52:67]
    s_setprio 2
    s_mov_b32 s51, 0x400000
    v_mov_b32 v249, 161800
L_mk_c3b:
    ds_read_b32 v248, v249
    s_waitcnt lgkmcnt(0)
    s_sub_u32 s51, s51, 1
    v_readfirstlane_b32 s49, v248
    s_cmp_eq_u32 s51, 0
    s_cbranch_scc1 L_mk_c3bgo
    s_cmp_ge_u32 s49, 4
    s_cbranch_scc1 L_mk_c3bgo
    s_sleep 1
    s_branch L_mk_c3b
L_mk_c3bgo:
    s_setprio 0
    s_waitcnt vmcnt(26) lgkmcnt(0)
    v_mfma_f32_32x32x16_bf16 v[4:19], v[232:235], v[184:187], v[4:19]
    ds_read_b128 v[224:227], v87 offset:0
    ds_read_b128 v[228:231], v87 offset:12768
    v_mfma_f32_32x32x16_bf16 v[20:35], v[232:235], v[188:191], v[20:35]
    buffer_load_dwordx4 v[104:107], v2, s[36:39], s54 offen offset:1024 sc1
    buffer_load_dwordx4 v[108:111], v2, s[36:39], s56 offen offset:1024 sc1
    v_mfma_f32_32x32x16_bf16 v[36:51], v[236:239], v[184:187], v[36:51]
    v_mfma_f32_32x32x16_bf16 v[52:67], v[236:239], v[188:191], v[52:67]
    s_waitcnt vmcnt(26) lgkmcnt(0)
    v_mfma_f32_32x32x16_bf16 v[4:19], v[224:227], v[192:195], v[4:19]
    ds_read_b128 v[232:235], v87 offset:25536
    ds_read_b128 v[236:239], v87 offset:38304
    v_mfma_f32_32x32x16_bf16 v[20:35], v[224:227], v[196:199], v[20:35]
    buffer_load_dwordx4 v[112:115], v2, s[36:39], s54 offen offset:2048 sc1
    buffer_load_dwordx4 v[116:119], v2, s[36:39], s56 offen offset:2048 sc1
    v_mfma_f32_32x32x16_bf16 v[36:51], v[228:231], v[192:195], v[36:51]
    v_mfma_f32_32x32x16_bf16 v[52:67], v[228:231], v[196:199], v[52:67]
    s_waitcnt vmcnt(18) lgkmcnt(0)
    v_mfma_f32_32x32x16_bf16 v[4:19], v[232:235], v[200:203], v[4:19]
    ds_read_b128 v[224:227], v87 offset:1024
    ds_read_b128 v[228:231], v87 offset:13792
    buffer_load_dwordx4 v[120:123], v2, s[36:39], s54 offen offset:3072 sc1
    v_mfma_f32_32x32x16_bf16 v[20:35], v[232:235], v[204:207], v[20:35]
    buffer_load_dwordx4 v[124:127], v2, s[36:39], s56 offen offset:3072 sc1
    s_add_u32 s3, s3, 4096
    s_cmp_eq_u32 s3, 32768
    v_mfma_f32_32x32x16_bf16 v[36:51], v[236:239], v[200:203], v[36:51]
    s_cselect_b32 s3, 0, s3
    s_add_u32 s54, s46, s3
    s_add_u32 s56, s47, s3
    v_mfma_f32_32x32x16_bf16 v[52:67], v[236:239], v[204:207], v[52:67]
    s_waitcnt vmcnt(16) lgkmcnt(0)
    v_mfma_f32_32x32x16_bf16 v[4:19], v[224:227], v[208:211], v[4:19]
    ds_read_b128 v[232:235], v87 offset:26560
    ds_read_b128 v[236:239], v87 offset:39328
    v_mfma_f32_32x32x16_bf16 v[20:35], v[224:227], v[212:215], v[20:35]
    buffer_load_dwordx4 v[128:131], v2, s[36:39], s54 offen offset:0 sc1
    buffer_load_dwordx4 v[132:135], v2, s[36:39], s56 offen offset:0 sc1
    v_mfma_f32_32x32x16_bf16 v[36:51], v[228:231], v[208:211], v[36:51]
    v_mfma_f32_32x32x16_bf16 v[52:67], v[228:231], v[212:215], v[52:67]
    s_setprio 2
    v_pk_add_f32 v[68:69], v[68:69], v[76:77]
    v_pk_add_f32 v[70:71], v[70:71], v[78:79]
    v_pk_add_f32 v[72:73], v[72:73], v[80:81]
    v_pk_add_f32 v[74:75], v[74:75], v[82:83]
    v_pk_add_f32 v[68:69], v[68:69], v[72:73]
    v_pk_add_f32 v[70:71], v[70:71], v[74:75]
    v_pk_add_f32 v[92:93], v[68:69], v[70:71]
    s_setprio 0
    s_waitcnt vmcnt(14) lgkmcnt(0)
    v_mfma_f32_32x32x16_bf16 v[4:19], v[232:235], v[216:219], v[4:19]
    ds_read_b128 v[224:227], v87 offset:2128
    ds_read_b128 v[228:231], v87 offset:14896
    buffer_load_dwordx4 v[136:139], v2, s[36:39], s54 offen offset:1024 sc1
    buffer_load_dwordx4 v[140:143], v2, s[36:39], s56 offen offset:1024 sc1
    v_mfma_f32_32x32x16_bf16 v[20:35], v[232:235], v[220:223], v[20:35]
    buffer_load_dwordx2 v[68:69], v84, s[36:39], s45 offen offset:0 sc1
    buffer_load_dwordx2 v[70:71], v84, s[36:39], s45 offen offset:512 sc1
    buffer_load_dwordx2 v[72:73], v84, s[36:39], s45 offen offset:1024 sc1
    buffer_load_dwordx2 v[74:75], v84, s[36:39], s45 offen offset:1536 sc1
    v_mfma_f32_32x32x16_bf16 v[36:51], v[236:239], v[216:219], v[36:51]
    buffer_load_dwordx2 v[76:77], v84, s[36:39], s45 offen offset:2048 sc1
    buffer_load_dwordx2 v[78:79], v84, s[36:39], s45 offen offset:2560 sc1
    buffer_load_dwordx2 v[80:81], v84, s[36:39], s45 offen offset:3072 sc1
    buffer_load_dwordx2 v[82:83], v84, s[36:39], s45 offen offset:3584 sc1
    v_mfma_f32_32x32x16_bf16 v[52:67], v[236:239], v[220:223], v[52:67]
    s_waitcnt vmcnt(20) lgkmcnt(0)
    v_mfma_f32_32x32x16_bf16 v[4:19], v[224:227], v[96:99], v[4:19]
    ds_read_b128 v[232:235], v87 offset:27664
    ds_read_b128 v[236:239], v87 offset:40432
    v_mfma_f32_32x32x16_bf16 v[20:35], v[224:227], v[100:103], v[20:35]
    buffer_load_dwordx4 v[144:147], v2, s[36:39], s54 offen offset:2048 sc1
    buffer_load_dwordx4 v[148:151], v2, s[36:39], s56 offen offset:2048 sc1
    v_mfma_f32_32x32x16_bf16 v[36:51], v[228:231], v[96:99], v[36:51]
    v_mfma_f32_32x32x16_bf16 v[52:67], v[228:231], v[100:103], v[52:67]
    s_waitcnt vmcnt(20)
    s_setprio 2
    v_mov_b32 v248, s65
    v_mov_b32 v249, 6
    ds_write_b32 v248, v249
    s_setprio 0
    s_waitcnt vmcnt(18) lgkmcnt(0)
    v_mfma_f32_32x32x16_bf16 v[4:19], v[232:235], v[104:107], v[4:19]
    ds_read_b128 v[224:227], v87 offset:3152
    ds_read_b128 v[228:231], v87 offset:15920
    buffer_load_dwordx4 v[152:155], v2, s[36:39], s54 offen offset:3072 sc1
    v_mfma_f32_32x32x16_bf16 v[20:35], v[232:235], v[108:111], v[20:35]
    buffer_load_dwordx4 v[156:159], v2, s[36:39], s56 offen offset:3072 sc1
    s_add_u32 s3, s3, 4096
    s_cmp_eq_u32 s3, 32768
    v_mfma_f32_32x32x16_bf16 v[36:51], v[236:239], v[104:107], v[36:51]
    s_cselect_b32 s3, 0, s3
    s_add_u32 s54, s46, s3
    s_add_u32 s56, s47, s3
    v_mfma_f32_32x32x16_bf16 v[52:67], v[236:239], v[108:111], v[52:67]
    s_setprio 2
    s_mov_b32 s51, 0x400000
    v_mov_b32 v252, 161760
L_mk_pw2:
    ds_read_b128 v[248:251], v252
    s_waitcnt lgkmcnt(0)
    v_min3_u32 v248, v248, v249, v250
    v_min_u32 v248, v248, v251
    s_sub_u32 s51, s51, 1
    v_readfirstlane_b32 s49, v248
    s_cmp_eq_u32 s51, 0
    s_cbranch_scc1 L_mk_pw2go
    s_cmp_ge_u32 s49, 24
    s_cbranch_scc1 L_mk_pw2go
    s_sleep 2
    s_branch L_mk_pw2
L_mk_pw2go:
    s_setprio 0
    s_waitcnt vmcnt(18) lgkmcnt(0)
    v_mfma_f32_32x32x16_bf16 v[4:19], v[224:227], v[112:115], v[4:19]
    ds_read_b128 v[232:235], v87 offset:28688
    ds_read_b128 v[236:239], v87 offset:41456
    buffer_load_dwordx4 v[160:163], v2, s[36:39], s54 offen offset:0 sc1
    buffer_load_dwordx4 v[164:167], v2, s[36:39], s56 offen offset:0 sc1
    v_mfma_f32_32x32x16_bf16 v[20:35], v[224:227], v[116:119], v[20:35]
    s_mov_b32 m0, s64
    s_and_b32 s16, s63, 0x1ffff
    s_add_u32 s16, s16, s59
    s_add_u32 s64, s64, 8512
    v_mfma_f32_32x32x16_bf16 v[36:51], v[228:231], v[112:115], v[36:51]
    buffer_load_dwordx4 v2, s[36:39], s16 offen sc1 lds
    buffer_load_dwordx4 v2, s[36:39], s16 offen offset:1024 sc1 lds
    s_add_u32 s63, s63, 8192
    v_mfma_f32_32x32x16_bf16 v[52:67], v[228:231], v[116:119], v[52:67]
    s_waitcnt vmcnt(20) lgkmcnt(0)
    v_mfma_f32_32x32x16_bf16 v[4:19], v[232:235], v[120:123], v[4:19]
    ds_read_b128 v[224:227], v87 offset:4256
    ds_read_b128 v[228:231], v87 offset:17024
    buffer_load_dwordx4 v[168:171], v2, s[36:39], s54 offen offset:1024 sc1
    buffer_load_dwordx4 v[172:175], v2, s[36:39], s56 offen offset:1024 sc1
    v_mfma_f32_32x32x16_bf16 v[20:35], v[232:235], v[124:127], v[20:35]
    s_mov_b32 m0, s64
    s_and_b32 s16, s63, 0x1ffff
    s_add_u32 s16, s16, s59
    s_add_u32 s64, s64, 8512
    v_mfma_f32_32x32x16_bf16 v[36:51], v[236:239], v[120:123], v[36:51]
    buffer_load_dwordx4 v2, s[36:39], s16 offen sc1 lds
    buffer_load_dwordx4 v2, s[36:39], s16 offen offset:1024 sc1 lds
    s_add_u32 s63, s63, 8192
    v_mfma_f32_32x32x16_bf16 v[52:67], v[236:239], v[124:127], v[52:67]
    s_waitcnt vmcnt(22) lgkmcnt(0)
    v_mfma_f32_32x32x16_bf16 v[4:19], v[224:227], v[128:131], v[4:19]
    ds_read_b128 v[232:235], v87 offset:29792
    ds_read_b128 v[236:239], v87 offset:42560
    v_mfma_f32_32x32x16_bf16 v[20:35], v[224:227], v[132:135], v[20:35]
    buffer_load_dwordx4 v[176:179], v2, s[36:39], s54 offen offset:2048 sc1
    buffer_load_dwordx4 v[180:183], v2, s[36:39], s56 offen offset:2048 sc1
    v_mfma_f32_32x32x16_bf16 v[36:51], v[228:231], v[128:131], v[36:51]
    buffer_load_dwordx4 v[240:243], v2, s[36:39], s50 offen offset:0 sc1
    buffer_load_dwordx4 v[244:247], v2, s[36:39], s50 offen offset:1024 sc1
    v_mfma_f32_32x32x16_bf16 v[52:67], v[228:231], v[132:135], v[52:67]
    s_waitcnt vmcnt(24) lgkmcnt(0)
    v_mfma_f32_32x32x16_bf16 v[4:19], v[232:235], v[136:139], v[4:19]
    ds_read_b128 v[224:227], v87 offset:5280
    ds_read_b128 v[228:231], v87 offset:18048
    buffer_load_dwordx4 v[184:187], v2, s[36:39], s54 offen offset:3072 sc1
    v_mfma_f32_32x32x16_bf16 v[20:35], v[232:235], v[140:143], v[20:35]
    buffer_load_dwordx4 v[188:191], v2, s[36:39], s56 offen offset:3072 sc1
    s_add_u32 s3, s3, 4096
    s_cmp_eq_u32 s3, 32768
    v_mfma_f32_32x32x16_bf16 v[36:51], v[236:239], v[136:139], v[36:51]
    s_cselect_b32 s3, 0, s3
    s_add_u32 s54, s46, s3
    s_add_u32 s56, s47, s3
    v_mfma_f32_32x32x16_bf16 v[52:67], v[236:239], v[140:143], v[52:67]
    s_waitcnt vmcnt(16) lgkmcnt(0)
    v_mfma_f32_32x32x16_bf16 v[4:19], v[224:227], v[144:147], v[4:19]
    ds_read_b128 v[232:235], v87 offset:30816
    ds_read_b128 v[236:239], v87 offset:43584
    v_mfma_f32_32x32x16_bf16 v[20:35], v[224:227], v[148:151], v[20:35]
    buffer_load_dwordx4 v[192:195], v2, s[36:39], s54 offen offset:0 sc1
    buffer_load_dwordx4 v[196:199], v2, s[36:39], s56 offen offset:0 sc1
    v_mfma_f32_32x32x16_bf16 v[36:51], v[228:231], v[144:147], v[36:51]
    v_mfma_f32_32x32x16_bf16 v[52:67], v[228:231], v[148:151], v[52:67]
    s_waitcnt vmcnt(16) lgkmcnt(0)
    v_mfma_f32_32x32x16_bf16 v[4:19], v[232:235], v[152:155], v[4:19]
    ds_read_b128 v[224:227], v87 offset:6384
    ds_read_b128 v[228:231], v87 offset:19152
    v_mfma_f32_32x32x16_bf16 v[20:35], v[232:235], v[156:159], v[20:35]
    buffer_load_dwordx4 v[200:203], v2, s[36:39], s54 offen offset:1024 sc1
    buffer_load_dwordx4 v[204:207], v2, s[36:39], s56 offen offset:1024 sc1
    v_mfma_f32_32x32x16_bf16 v[36:51], v[236:239], v[152:155], v[36:51]
    v_mfma_f32_32x32x16_bf16 v[52:67], v[236:239], v[156:159], v[52:67]
    s_waitcnt vmcnt(16) lgkmcnt(0)
    v_mfma_f32_32x32x16_bf16 v[4:19], v[224:227], v[160:163], v[4:19]
    ds_read_b128 v[232:235], v87 offset:31920
    ds_read_b128 v[236:239], v87 offset:44688
    v_mfma_f32_32x32x16_bf16 v[20:35], v[224:227], v[164:167], v[20:35]
    buffer_load_dwordx4 v[208:211], v2, s[36:39], s54 offen offset:2048 sc1
    buffer_load_dwordx4 v[212:215], v2, s[36:39], s56 offen offset:2048 sc1
    v_mfma_f32_32x32x16_bf16 v[36:51], v[228:231], v[160:163], v[36:51]
    v_mfma_f32_32x32x16_bf16 v[52:67], v[228:231], v[164:167], v[52:67]
    s_waitcnt vmcnt(14) lgkmcnt(0)
    v_mfma_f32_32x32x16_bf16 v[4:19], v[232:235], v[168:171], v[4:19]
    ds_read_b128 v[224:227], v87 offset:7408
    ds_read_b128 v[228:231], v87 offset:20176
    v_mfma_f32_32x32x16_bf16 v[20:35], v[232:235], v[172:175], v[20:35]
    buffer_load_dwordx4 v[216:219], v2, s[36:39], s54 offen offset:3072 sc1
    buffer_load_dwordx4 v[220:223], v2, s[36:39], s56 offen offset:3072 sc1
    v_mfma_f32_32x32x16_bf16 v[36:51], v[236:239], v[168:171], v[36:51]
    v_mfma_f32_32x32x16_bf16 v[52:67], v[236:239], v[172:175], v[52:67]
    s_waitcnt vmcnt(14)
    s_setprio 2
    v_mov_b32 v248, s65
    v_mov_b32 v249, 7
    ds_write_b32 v248, v249
    s_setprio 0
    s_waitcnt vmcnt(12) lgkmcnt(0)
    v_mfma_f32_32x32x16_bf16 v[4:19], v[224:227], v[176:179], v[4:19]
    ds_read_b128 v[232:235], v87 offset:32944
    ds_read_b128 v[236:239], v87 offset:45712
    s_and_b32 s41, s2, 7
    s_lshl_b32 s41, s41, 2
    s_bfe_u32 s42, s2, 0x20003
    s_add_u32 s41, s41, s42
    s_lshr_b32 s42, s2, 5
    s_lshl_b32 s41, s41, 1
    s_lshl_b32 s42, s42, 1
    v_mfma_f32_32x32x16_bf16 v[20:35], v[224:227], v[180:183], v[20:35]
    s_mul_i32 s43, s60, 28672
    s_mul_i32 s44, s42, 114688
    s_add_u32 s44, s44, s43
    s_add_u32 s44, s44, 0xb00000
    s_add_u32 s45, s44, 114688
    s_lshr_b32 s55, s2, 5
    s_bfe_u32 s43, s2, 0x20003
    s_lshl_b32 s43, s43, 1
    s_add_u32 s55, s55, s43
    v_mfma_f32_32x32x16_bf16 v[36:51], v[228:231], v[176:179], v[36:51]
    s_and_b32 s55, s55, 15
    s_cmp_ge_u32 s55, 7
    s_cselect_b32 s43, 7, 0
    s_sub_u32 s55, s55, s43
    s_lshl_b32 s58, s55, 12
    s_add_u32 s56, s44, s58
    s_add_u32 s57, s45, s58
    buffer_load_dwordx4 v[96:99], v2, s[36:39], s56 offen offset:0 sc1
    buffer_load_dwordx4 v[100:103], v2, s[36:39], s57 offen offset:0 sc1
    v_mfma_f32_32x32x16_bf16 v[52:67], v[228:231], v[180:183], v[52:67]
    s_waitcnt vmcnt(10) lgkmcnt(0)
    v_mfma_f32_32x32x16_bf16 v[4:19], v[232:235], v[184:187], v[4:19]
    ds_read_b128 v[224:227], v87 offset:8512
    ds_read_b128 v[228:231], v87 offset:21280
    v_mfma_f32_32x32x16_bf16 v[20:35], v[232:235], v[188:191], v[20:35]
    buffer_load_dwordx4 v[104:107], v2, s[36:39], s56 offen offset:1024 sc1
    buffer_load_dwordx4 v[108:111], v2, s[36:39], s57 offen offset:1024 sc1
    v_mfma_f32_32x32x16_bf16 v[36:51], v[236:239], v[184:187], v[36:51]
    v_mfma_f32_32x32x16_bf16 v[52:67], v[236:239], v[188:191], v[52:67]
    s_waitcnt vmcnt(10) lgkmcnt(0)
    v_mfma_f32_32x32x16_bf16 v[4:19], v[224:227], v[192:195], v[4:19]
    ds_read_b128 v[232:235], v87 offset:34048
    ds_read_b128 v[236:239], v87 offset:46816
    v_mfma_f32_32x32x16_bf16 v[20:35], v[224:227], v[196:199], v[20:35]
    buffer_load_dwordx4 v[112:115], v2, s[36:39], s56 offen offset:2048 sc1
    buffer_load_dwordx4 v[116:119], v2, s[36:39], s57 offen offset:2048 sc1
    v_mfma_f32_32x32x16_bf16 v[36:51], v[228:231], v[192:195], v[36:51]
    v_mfma_f32_32x32x16_bf16 v[52:67], v[228:231], v[196:199], v[52:67]
    s_setprio 2
    v_pk_add_f32 v[68:69], v[68:69], v[76:77]
    v_pk_add_f32 v[70:71], v[70:71], v[78:79]
    v_pk_add_f32 v[72:73], v[72:73], v[80:81]
    v_pk_add_f32 v[74:75], v[74:75], v[82:83]
    v_pk_add_f32 v[68:69], v[68:69], v[72:73]
    v_pk_add_f32 v[70:71], v[70:71], v[74:75]
    v_pk_add_f32 v[94:95], v[68:69], v[70:71]
    v_mov_b32 v248, v92
    v_mov_b32 v249, v93
    s_nop 0
    v_permlane32_swap_b32 v248, v92
    v_permlane32_swap_b32 v249, v93
    s_nop 1
    v_add_f32 v92, v92, v248
    v_add_f32 v93, v93, v249
    v_mul_f32 v92, 0xbb000000, v92
    v_mul_f32 v248, v92, v92
    v_mul_f32 v93, 0x3b000000, v93
    v_sub_f32 v93, v93, v248
    v_max_f32 v93, 0, v93
    v_add_f32 v93, 0x3727c5ac, v93
    v_rsq_f32 v249, v93
    v_sqrt_f32 v78, v93
    v_cvt_pk_bf16_f32 v68, v92, v92
    v_and_b32 v248, 0xffff0000, v68
    v_sub_f32 v248, v92, v248
    v_cvt_pk_bf16_f32 v69, v248, 0
    v_mov_b32 v70, v68
    v_mov_b32 v71, v69
    v_mul_f32 v77, 0xc0135761, v249
    v_mul_f32 v248, v249, v249
    v_mul_f32 v248, v248, v249
    v_mul_f32 v76, 0xbdd2d3e8, v248
    v_mov_b32 v248, v94
    v_mov_b32 v249, v95
    s_nop 0
    v_permlane32_swap_b32 v248, v94
    v_permlane32_swap_b32 v249, v95
    s_nop 1
    v_add_f32 v94, v94, v248
    v_add_f32 v95, v95, v249
    v_mul_f32 v94, 0xbb000000, v94
    v_mul_f32 v248, v94, v94
    v_mul_f32 v95, 0x3b000000, v95
    v_sub_f32 v95, v95, v248
    v_max_f32 v95, 0, v95
    v_add_f32 v95, 0x3727c5ac, v95
    v_rsq_f32 v249, v95
    v_sqrt_f32 v82, v95
    v_cvt_pk_bf16_f32 v72, v94, v94
    v_and_b32 v248, 0xffff0000, v72
    v_sub_f32 v248, v94, v248
    v_cvt_pk_bf16_f32 v73, v248, 0
    v_mov_b32 v74, v72
    v_mov_b32 v75, v73
    v_mul_f32 v81, 0xc0135761, v249
    v_mul_f32 v248, v249, v249
    v_mul_f32 v248, v248, v249
    v_mul_f32 v80, 0xbdd2d3e8, v248
    s_setprio 0
    s_waitcnt vmcnt(10) lgkmcnt(0)
    v_mfma_f32_32x32x16_bf16 v[4:19], v[232:235], v[200:203], v[4:19]
    ds_read_b128 v[224:227], v87 offset:9536
    ds_read_b128 v[228:231], v87 offset:22304
    buffer_load_dwordx4 v[120:123], v2, s[36:39], s56 offen offset:3072 sc1
    v_mfma_f32_32x32x16_bf16 v[20:35], v[232:235], v[204:207], v[20:35]
    buffer_load_dwordx4 v[124:127], v2, s[36:39], s57 offen offset:3072 sc1
    s_add_u32 s58, s58, 4096
    s_cmp_eq_u32 s58, 28672
    v_mfma_f32_32x32x16_bf16 v[36:51], v[236:239], v[200:203], v[36:51]
    s_cselect_b32 s58, 0, s58
    s_add_u32 s56, s44, s58
    s_add_u32 s57, s45, s58
    v_mfma_f32_32x32x16_bf16 v[52:67], v[236:239], v[204:207], v[52:67]
    s_waitcnt vmcnt(10) lgkmcnt(0)
    v_mfma_f32_32x32x16_bf16 v[4:19], v[224:227], v[208:211], v[4:19]
    ds_read_b128 v[232:235], v87 offset:35072
    ds_read_b128 v[236:239], v87 offset:47840
    v_mfma_f32_32x32x16_bf16 v[20:35], v[224:227], v[212:215], v[20:35]
    buffer_load_dwordx4 v[128:131], v2, s[36:39], s56 offen offset:0 sc1
    buffer_load_dwordx4 v[132:135], v2, s[36:39], s57 offen offset:0 sc1
    v_mfma_f32_32x32x16_bf16 v[36:51], v[228:231], v[208:211], v[36:51]
    v_mfma_f32_32x32x16_bf16 v[52:67], v[228:231], v[212:215], v[52:67]
    s_waitcnt vmcnt(10) lgkmcnt(0)
    v_mfma_f32_32x32x16_bf16 v[4:19], v[232:235], v[216:219], v[4:19]
    buffer_load_dwordx4 v[136:139], v2, s[36:39], s56 offen offset:1024 sc1
    v_mfma_f32_32x32x16_bf16 v[20:35], v[232:235], v[220:223], v[20:35]
    buffer_load_dwordx4 v[140:143], v2, s[36:39], s57 offen offset:1024 sc1
    v_mfma_f32_32x32x16_bf16 v[36:51], v[236:239], v[216:219], v[36:51]
    v_mfma_f32_32x32x16_bf16 v[52:67], v[236:239], v[220:223], v[52:67]
    v_mfma_f32_32x32x16_bf16 v[4:19], v[240:243], v[68:71], v[4:19]
    v_mfma_f32_32x32x16_bf16 v[20:35], v[240:243], v[72:75], v[20:35]
    v_mfma_f32_32x32x16_bf16 v[36:51], v[244:247], v[68:71], v[36:51]
    v_mfma_f32_32x32x16_bf16 v[52:67], v[244:247], v[72:75], v[52:67]
    buffer_load_dwordx4 v[144:147], v2, s[36:39], s56 offen offset:2048 sc1
    buffer_load_dwordx4 v[148:151], v2, s[36:39], s57 offen offset:2048 sc1
    buffer_load_dwordx4 v[152:155], v2, s[36:39], s56 offen offset:3072 sc1
    buffer_load_dwordx4 v[156:159], v2, s[36:39], s57 offen offset:3072 sc1
    s_add_u32 s58, s58, 4096
    s_cmp_eq_u32 s58, 28672
    s_cselect_b32 s58, 0, s58
    s_add_u32 s56, s44, s58
    s_add_u32 s57, s45, s58
    s_setprio 2
    s_mov_b32 s46, s48
    s_mul_i32 s54, s60, 17024
    s_add_u32 s54, s54, 85120
    v_add_u32 v88, s54, v2
    s_add_u32 s50, s55, 5
    s_cmp_ge_u32 s50, 7
    s_cselect_b32 s43, 7, 0
    s_sub_u32 s50, s50, s43
    s_sub_u32 s48, s45, 1024
    s_lshl_b32 s3, s50, 12
    s_add_u32 s52, s44, s3
    s_add_u32 s53, s48, s3
    s_add_u32 s47, s46, 114688
    v_pk_mul_f32 v[160:161], v[4:5], v[4:5]
    v_pk_mul_f32 v[162:163], v[6:7], v[6:7]
    v_pk_mul_f32 v[164:165], v[8:9], v[8:9]
    v_pk_mul_f32 v[166:167], v[10:11], v[10:11]
    v_pk_mul_f32 v[168:169], v[12:13], v[12:13]
    v_pk_mul_f32 v[170:171], v[14:15], v[14:15]
    v_pk_mul_f32 v[172:173], v[16:17], v[16:17]
    v_pk_mul_f32 v[174:175], v[18:19], v[18:19]
    v_pk_fma_f32 v[160:161], v[160:161], v[76:77], v[76:77] op_sel:[0,0,1] op_sel_hi:[1,0,1]
    v_pk_fma_f32 v[162:163], v[162:163], v[76:77], v[76:77] op_sel:[0,0,1] op_sel_hi:[1,0,1]
    v_pk_fma_f32 v[164:165], v[164:165], v[76:77], v[76:77] op_sel:[0,0,1] op_sel_hi:[1,0,1]
    v_pk_fma_f32 v[166:167], v[166:167], v[76:77], v[76:77] op_sel:[0,0,1] op_sel_hi:[1,0,1]
    v_pk_fma_f32 v[168:169], v[168:169], v[76:77], v[76:77] op_sel:[0,0,1] op_sel_hi:[1,0,1]
    v_pk_fma_f32 v[170:171], v[170:171], v[76:77], v[76:77] op_sel:[0,0,1] op_sel_hi:[1,0,1]
    v_pk_fma_f32 v[172:173], v[172:173], v[76:77], v[76:77] op_sel:[0,0,1] op_sel_hi:[1,0,1]
    v_pk_fma_f32 v[174:175], v[174:175], v[76:77], v[76:77] op_sel:[0,0,1] op_sel_hi:[1,0,1]
    v_pk_mul_f32 v[160:161], v[160:161], v[4:5]
    v_pk_mul_f32 v[162:163], v[162:163], v[6:7]
    v_pk_mul_f32 v[164:165], v[164:165], v[8:9]
    v_pk_mul_f32 v[166:167], v[166:167], v[10:11]
    v_pk_mul_f32 v[168:169], v[168:169], v[12:13]
    v_pk_mul_f32 v[170:171], v[170:171], v[14:15]
    v_pk_mul_f32 v[172:173], v[172:173], v[16:17]
    v_pk_mul_f32 v[174:175], v[174:175], v[18:19]
    v_exp_f32 v160, v160
    v_exp_f32 v161, v161
    v_exp_f32 v162, v162
    v_exp_f32 v163, v163
    v_exp_f32 v164, v164
    v_exp_f32 v165, v165
    v_exp_f32 v166, v166
    v_exp_f32 v167, v167
    v_exp_f32 v168, v168
    v_exp_f32 v169, v169
    v_exp_f32 v170, v170
    v_exp_f32 v171, v171
    v_exp_f32 v172, v172
    v_exp_f32 v173, v173
    v_exp_f32 v174, v174
    v_exp_f32 v175, v175
    v_pk_fma_f32 v[160:161], v[160:161], v[78:79], v[78:79] op_sel_hi:[1,0,0]
    v_pk_fma_f32 v[162:163], v[162:163], v[78:79], v[78:79] op_sel_hi:[1,0,0]
    v_pk_fma_f32 v[164:165], v[164:165], v[78:79], v[78:79] op_sel_hi:[1,0,0]
    v_pk_fma_f32 v[166:167], v[166:167], v[78:79], v[78:79] op_sel_hi:[1,0,0]
    v_pk_fma_f32 v[168:169], v[168:169], v[78:79], v[78:79] op_sel_hi:[1,0,0]
    v_pk_fma_f32 v[170:171], v[170:171], v[78:79], v[78:79] op_sel_hi:[1,0,0]
    v_pk_fma_f32 v[172:173], v[172:173], v[78:79], v[78:79] op_sel_hi:[1,0,0]
    v_pk_fma_f32 v[174:175], v[174:175], v[78:79], v[78:79] op_sel_hi:[1,0,0]
    v_rcp_f32 v160, v160
    v_rcp_f32 v161, v161
    v_rcp_f32 v162, v162
    v_rcp_f32 v163, v163
    v_rcp_f32 v164, v164
    v_rcp_f32 v165, v165
    v_rcp_f32 v166, v166
    v_rcp_f32 v167, v167
    v_rcp_f32 v168, v168
    v_rcp_f32 v169, v169
    v_rcp_f32 v170, v170
    v_rcp_f32 v171, v171
    v_rcp_f32 v172, v172
    v_rcp_f32 v173, v173
    v_rcp_f32 v174, v174
    v_rcp_f32 v175, v175
    v_pk_mul_f32 v[4:5], v[4:5], v[160:161]
    v_pk_mul_f32 v[6:7], v[6:7], v[162:163]
    v_pk_mul_f32 v[8:9], v[8:9], v[164:165]
    v_pk_mul_f32 v[10:11], v[10:11], v[166:167]
    v_pk_mul_f32 v[12:13], v[12:13], v[168:169]
    v_pk_mul_f32 v[14:15], v[14:15], v[170:171]
    v_pk_mul_f32 v[16:17], v[16:17], v[172:173]
    v_pk_mul_f32 v[18:19], v[18:19], v[174:175]
    v_cvt_pk_bf16_f32 v4, v4, v5
    v_cvt_pk_bf16_f32 v5, v6, v7
    v_cvt_pk_bf16_f32 v6, v8, v9
    v_cvt_pk_bf16_f32 v7, v10, v11
    v_cvt_pk_bf16_f32 v8, v12, v13
    v_cvt_pk_bf16_f32 v9, v14, v15
    v_cvt_pk_bf16_f32 v10, v16, v17
    v_cvt_pk_bf16_f32 v11, v18, v19
    buffer_store_dwordx4 v[4:7], v2, s[36:39], s46 offen offset:0 sc1
    buffer_store_dwordx4 v[8:11], v2, s[36:39], s46 offen offset:1024 sc1
    v_pk_mul_f32 v[160:161], v[20:21], v[20:21]
    v_pk_mul_f32 v[162:163], v[22:23], v[22:23]
    v_pk_mul_f32 v[164:165], v[24:25], v[24:25]
    v_pk_mul_f32 v[166:167], v[26:27], v[26:27]
    v_pk_mul_f32 v[168:169], v[28:29], v[28:29]
    v_pk_mul_f32 v[170:171], v[30:31], v[30:31]
    v_pk_mul_f32 v[172:173], v[32:33], v[32:33]
    v_pk_mul_f32 v[174:175], v[34:35], v[34:35]
    v_pk_fma_f32 v[160:161], v[160:161], v[80:81], v[80:81] op_sel:[0,0,1] op_sel_hi:[1,0,1]
    v_pk_fma_f32 v[162:163], v[162:163], v[80:81], v[80:81] op_sel:[0,0,1] op_sel_hi:[1,0,1]
    v_pk_fma_f32 v[164:165], v[164:165], v[80:81], v[80:81] op_sel:[0,0,1] op_sel_hi:[1,0,1]
    v_pk_fma_f32 v[166:167], v[166:167], v[80:81], v[80:81] op_sel:[0,0,1] op_sel_hi:[1,0,1]
    v_pk_fma_f32 v[168:169], v[168:169], v[80:81], v[80:81] op_sel:[0,0,1] op_sel_hi:[1,0,1]
    v_pk_fma_f32 v[170:171], v[170:171], v[80:81], v[80:81] op_sel:[0,0,1] op_sel_hi:[1,0,1]
    v_pk_fma_f32 v[172:173], v[172:173], v[80:81], v[80:81] op_sel:[0,0,1] op_sel_hi:[1,0,1]
    v_pk_fma_f32 v[174:175], v[174:175], v[80:81], v[80:81] op_sel:[0,0,1] op_sel_hi:[1,0,1]
    v_pk_mul_f32 v[160:161], v[160:161], v[20:21]
    v_pk_mul_f32 v[162:163], v[162:163], v[22:23]
    v_pk_mul_f32 v[164:165], v[164:165], v[24:25]
    v_pk_mul_f32 v[166:167], v[166:167], v[26:27]
    v_pk_mul_f32 v[168:169], v[168:169], v[28:29]
    v_pk_mul_f32 v[170:171], v[170:171], v[30:31]
    v_pk_mul_f32 v[172:173], v[172:173], v[32:33]
    v_pk_mul_f32 v[174:175], v[174:175], v[34:35]
    v_exp_f32 v160, v160
    v_exp_f32 v161, v161
    v_exp_f32 v162, v162
    v_exp_f32 v163, v163
    v_exp_f32 v164, v164
    v_exp_f32 v165, v165
    v_exp_f32 v166, v166
    v_exp_f32 v167, v167
    v_exp_f32 v168, v168
    v_exp_f32 v169, v169
    v_exp_f32 v170, v170
    v_exp_f32 v171, v171
    v_exp_f32 v172, v172
    v_exp_f32 v173, v173
    v_exp_f32 v174, v174
    v_exp_f32 v175, v175
    v_pk_fma_f32 v[160:161], v[160:161], v[82:83], v[82:83] op_sel_hi:[1,0,0]
    v_pk_fma_f32 v[162:163], v[162:163], v[82:83], v[82:83] op_sel_hi:[1,0,0]
    v_pk_fma_f32 v[164:165], v[164:165], v[82:83], v[82:83] op_sel_hi:[1,0,0]
    v_pk_fma_f32 v[166:167], v[166:167], v[82:83], v[82:83] op_sel_hi:[1,0,0]
    v_pk_fma_f32 v[168:169], v[168:169], v[82:83], v[82:83] op_sel_hi:[1,0,0]
    v_pk_fma_f32 v[170:171], v[170:171], v[82:83], v[82:83] op_sel_hi:[1,0,0]
    v_pk_fma_f32 v[172:173], v[172:173], v[82:83], v[82:83] op_sel_hi:[1,0,0]
    v_pk_fma_f32 v[174:175], v[174:175], v[82:83], v[82:83] op_sel_hi:[1,0,0]
    v_rcp_f32 v160, v160
    v_rcp_f32 v161, v161
    v_rcp_f32 v162, v162
    v_rcp_f32 v163, v163
    v_rcp_f32 v164, v164
    v_rcp_f32 v165, v165
    v_rcp_f32 v166, v166
    v_rcp_f32 v167, v167
    v_rcp_f32 v168, v168
    v_rcp_f32 v169, v169
    v_rcp_f32 v170, v170
    v_rcp_f32 v171, v171
    v_rcp_f32 v172, v172
    v_rcp_f32 v173, v173
    v_rcp_f32 v174, v174
    v_rcp_f32 v175, v175
    v_pk_mul_f32 v[20:21], v[20:21], v[160:161]
    v_pk_mul_f32 v[22:23], v[22:23], v[162:163]
    v_pk_mul_f32 v[24:25], v[24:25], v[164:165]
    v_pk_mul_f32 v[26:27], v[26:27], v[166:167]
    v_pk_mul_f32 v[28:29], v[28:29], v[168:169]
    v_pk_mul_f32 v[30:31], v[30:31], v[170:171]
    v_pk_mul_f32 v[32:33], v[32:33], v[172:173]
    v_pk_mul_f32 v[34:35], v[34:35], v[174:175]
    v_cvt_pk_bf16_f32 v20, v20, v21
    v_cvt_pk_bf16_f32 v21, v22, v23
    v_cvt_pk_bf16_f32 v22, v24, v25
    v_cvt_pk_bf16_f32 v23, v26, v27
    v_cvt_pk_bf16_f32 v24, v28, v29
    v_cvt_pk_bf16_f32 v25, v30, v31
    v_cvt_pk_bf16_f32 v26, v32, v33
    v_cvt_pk_bf16_f32 v27, v34, v35
    buffer_store_dwordx4 v[20:23], v2, s[36:39], s47 offen offset:0 sc1
    buffer_store_dwordx4 v[24:27], v2, s[36:39], s47 offen offset:1024 sc1
    v_pk_mul_f32 v[160:161], v[36:37], v[36:37]
    v_pk_mul_f32 v[162:163], v[38:39], v[38:39]
    v_pk_mul_f32 v[164:165], v[40:41], v[40:41]
    v_pk_mul_f32 v[166:167], v[42:43], v[42:43]
    v_pk_mul_f32 v[168:169], v[44:45], v[44:45]
    v_pk_mul_f32 v[170:171], v[46:47], v[46:47]
    v_pk_mul_f32 v[172:173], v[48:49], v[48:49]
    v_pk_mul_f32 v[174:175], v[50:51], v[50:51]
    v_pk_fma_f32 v[160:161], v[160:161], v[76:77], v[76:77] op_sel:[0,0,1] op_sel_hi:[1,0,1]
    v_pk_fma_f32 v[162:163], v[162:163], v[76:77], v[76:77] op_sel:[0,0,1] op_sel_hi:[1,0,1]
    v_pk_fma_f32 v[164:165], v[164:165], v[76:77], v[76:77] op_sel:[0,0,1] op_sel_hi:[1,0,1]
    v_pk_fma_f32 v[166:167], v[166:167], v[76:77], v[76:77] op_sel:[0,0,1] op_sel_hi:[1,0,1]
    v_pk_fma_f32 v[168:169], v[168:169], v[76:77], v[76:77] op_sel:[0,0,1] op_sel_hi:[1,0,1]
    v_pk_fma_f32 v[170:171], v[170:171], v[76:77], v[76:77] op_sel:[0,0,1] op_sel_hi:[1,0,1]
    v_pk_fma_f32 v[172:173], v[172:173], v[76:77], v[76:77] op_sel:[0,0,1] op_sel_hi:[1,0,1]
    v_pk_fma_f32 v[174:175], v[174:175], v[76:77], v[76:77] op_sel:[0,0,1] op_sel_hi:[1,0,1]
    v_pk_mul_f32 v[160:161], v[160:161], v[36:37]
    v_pk_mul_f32 v[162:163], v[162:163], v[38:39]
    v_pk_mul_f32 v[164:165], v[164:165], v[40:41]
    v_pk_mul_f32 v[166:167], v[166:167], v[42:43]
    v_pk_mul_f32 v[168:169], v[168:169], v[44:45]
    v_pk_mul_f32 v[170:171], v[170:171], v[46:47]
    v_pk_mul_f32 v[172:173], v[172:173], v[48:49]
    v_pk_mul_f32 v[174:175], v[174:175], v[50:51]
    v_exp_f32 v160, v160
    v_exp_f32 v161, v161
    v_exp_f32 v162, v162
    v_exp_f32 v163, v163
    v_exp_f32 v164, v164
    v_exp_f32 v165, v165
    v_exp_f32 v166, v166
    v_exp_f32 v167, v167
    v_exp_f32 v168, v168
    v_exp_f32 v169, v169
    v_exp_f32 v170, v170
    v_exp_f32 v171, v171
    v_exp_f32 v172, v172
    v_exp_f32 v173, v173
    v_exp_f32 v174, v174
    v_exp_f32 v175, v175
    v_pk_fma_f32 v[160:161], v[160:161], v[78:79], v[78:79] op_sel_hi:[1,0,0]
    v_pk_fma_f32 v[162:163], v[162:163], v[78:79], v[78:79] op_sel_hi:[1,0,0]
    v_pk_fma_f32 v[164:165], v[164:165], v[78:79], v[78:79] op_sel_hi:[1,0,0]
    v_pk_fma_f32 v[166:167], v[166:167], v[78:79], v[78:79] op_sel_hi:[1,0,0]
    v_pk_fma_f32 v[168:169], v[168:169], v[78:79], v[78:79] op_sel_hi:[1,0,0]
    v_pk_fma_f32 v[170:171], v[170:171], v[78:79], v[78:79] op_sel_hi:[1,0,0]
    v_pk_fma_f32 v[172:173], v[172:173], v[78:79], v[78:79] op_sel_hi:[1,0,0]
    v_pk_fma_f32 v[174:175], v[174:175], v[78:79], v[78:79] op_sel_hi:[1,0,0]
    v_rcp_f32 v160, v160
    v_rcp_f32 v161, v161
    v_rcp_f32 v162, v162
    v_rcp_f32 v163, v163
    v_rcp_f32 v164, v164
    v_rcp_f32 v165, v165
    v_rcp_f32 v166, v166
    v_rcp_f32 v167, v167
    v_rcp_f32 v168, v168
    v_rcp_f32 v169, v169
    v_rcp_f32 v170, v170
    v_rcp_f32 v171, v171
    v_rcp_f32 v172, v172
    v_rcp_f32 v173, v173
    v_rcp_f32 v174, v174
    v_rcp_f32 v175, v175
    v_pk_mul_f32 v[36:37], v[36:37], v[160:161]
    v_pk_mul_f32 v[38:39], v[38:39], v[162:163]
    v_pk_mul_f32 v[40:41], v[40:41], v[164:165]
    v_pk_mul_f32 v[42:43], v[42:43], v[166:167]
    v_pk_mul_f32 v[44:45], v[44:45], v[168:169]
    v_pk_mul_f32 v[46:47], v[46:47], v[170:171]
    v_pk_mul_f32 v[48:49], v[48:49], v[172:173]
    v_pk_mul_f32 v[50:51], v[50:51], v[174:175]
    v_cvt_pk_bf16_f32 v36, v36, v37
    v_cvt_pk_bf16_f32 v37, v38, v39
    v_cvt_pk_bf16_f32 v38, v40, v41
    v_cvt_pk_bf16_f32 v39, v42, v43
    v_cvt_pk_bf16_f32 v40, v44, v45
    v_cvt_pk_bf16_f32 v41, v46, v47
    v_cvt_pk_bf16_f32 v42, v48, v49
    v_cvt_pk_bf16_f32 v43, v50, v51
    buffer_store_dwordx4 v[36:39], v2, s[36:39], s46 offen offset:2048 sc1
    buffer_store_dwordx4 v[40:43], v2, s[36:39], s46 offen offset:3072 sc1
    v_pk_mul_f32 v[160:161], v[52:53], v[52:53]
    v_pk_mul_f32 v[162:163], v[54:55], v[54:55]
    v_pk_mul_f32 v[164:165], v[56:57], v[56:57]
    v_pk_mul_f32 v[166:167], v[58:59], v[58:59]
    v_pk_mul_f32 v[168:169], v[60:61], v[60:61]
    v_pk_mul_f32 v[170:171], v[62:63], v[62:63]
    v_pk_mul_f32 v[172:173], v[64:65], v[64:65]
    v_pk_mul_f32 v[174:175], v[66:67], v[66:67]
    v_pk_fma_f32 v[160:161], v[160:161], v[80:81], v[80:81] op_sel:[0,0,1] op_sel_hi:[1,0,1]
    v_pk_fma_f32 v[162:163], v[162:163], v[80:81], v[80:81] op_sel:[0,0,1] op_sel_hi:[1,0,1]
    v_pk_fma_f32 v[164:165], v[164:165], v[80:81], v[80:81] op_sel:[0,0,1] op_sel_hi:[1,0,1]
    v_pk_fma_f32 v[166:167], v[166:167], v[80:81], v[80:81] op_sel:[0,0,1] op_sel_hi:[1,0,1]
    v_pk_fma_f32 v[168:169], v[168:169], v[80:81], v[80:81] op_sel:[0,0,1] op_sel_hi:[1,0,1]
    v_pk_fma_f32 v[170:171], v[170:171], v[80:81], v[80:81] op_sel:[0,0,1] op_sel_hi:[1,0,1]
    v_pk_fma_f32 v[172:173], v[172:173], v[80:81], v[80:81] op_sel:[0,0,1] op_sel_hi:[1,0,1]
    v_pk_fma_f32 v[174:175], v[174:175], v[80:81], v[80:81] op_sel:[0,0,1] op_sel_hi:[1,0,1]
    v_pk_mul_f32 v[160:161], v[160:161], v[52:53]
    v_pk_mul_f32 v[162:163], v[162:163], v[54:55]
    v_pk_mul_f32 v[164:165], v[164:165], v[56:57]
    v_pk_mul_f32 v[166:167], v[166:167], v[58:59]
    v_pk_mul_f32 v[168:169], v[168:169], v[60:61]
    v_pk_mul_f32 v[170:171], v[170:171], v[62:63]
    v_pk_mul_f32 v[172:173], v[172:173], v[64:65]
    v_pk_mul_f32 v[174:175], v[174:175], v[66:67]
    v_exp_f32 v160, v160
    v_exp_f32 v161, v161
    v_exp_f32 v162, v162
    v_exp_f32 v163, v163
    v_exp_f32 v164, v164
    v_exp_f32 v165, v165
    v_exp_f32 v166, v166
    v_exp_f32 v167, v167
    v_exp_f32 v168, v168
    v_exp_f32 v169, v169
    v_exp_f32 v170, v170
    v_exp_f32 v171, v171
    v_exp_f32 v172, v172
    v_exp_f32 v173, v173
    v_exp_f32 v174, v174
    v_exp_f32 v175, v175
    v_pk_fma_f32 v[160:161], v[160:161], v[82:83], v[82:83] op_sel_hi:[1,0,0]
    v_pk_fma_f32 v[162:163], v[162:163], v[82:83], v[82:83] op_sel_hi:[1,0,0]
    v_pk_fma_f32 v[164:165], v[164:165], v[82:83], v[82:83] op_sel_hi:[1,0,0]
    v_pk_fma_f32 v[166:167], v[166:167], v[82:83], v[82:83] op_sel_hi:[1,0,0]
    v_pk_fma_f32 v[168:169], v[168:169], v[82:83], v[82:83] op_sel_hi:[1,0,0]
    v_pk_fma_f32 v[170:171], v[170:171], v[82:83], v[82:83] op_sel_hi:[1,0,0]
    v_pk_fma_f32 v[172:173], v[172:173], v[82:83], v[82:83] op_sel_hi:[1,0,0]
    v_pk_fma_f32 v[174:175], v[174:175], v[82:83], v[82:83] op_sel_hi:[1,0,0]
    v_rcp_f32 v160, v160
    v_rcp_f32 v161, v161
    v_rcp_f32 v162, v162
    v_rcp_f32 v163, v163
    v_rcp_f32 v164, v164
    v_rcp_f32 v165, v165
    v_rcp_f32 v166, v166
    v_rcp_f32 v167, v167
    v_rcp_f32 v168, v168
    v_rcp_f32 v169, v169
    v_rcp_f32 v170, v170
    v_rcp_f32 v171, v171
    v_rcp_f32 v172, v172
    v_rcp_f32 v173, v173
    v_rcp_f32 v174, v174
    v_rcp_f32 v175, v175
    v_pk_mul_f32 v[52:53], v[52:53], v[160:161]
    v_pk_mul_f32 v[54:55], v[54:55], v[162:163]
    v_pk_mul_f32 v[56:57], v[56:57], v[164:165]
    v_pk_mul_f32 v[58:59], v[58:59], v[166:167]
    v_pk_mul_f32 v[60:61], v[60:61], v[168:169]
    v_pk_mul_f32 v[62:63], v[62:63], v[170:171]
    v_pk_mul_f32 v[64:65], v[64:65], v[172:173]
    v_pk_mul_f32 v[66:67], v[66:67], v[174:175]
    v_cvt_pk_bf16_f32 v52, v52, v53
    v_cvt_pk_bf16_f32 v53, v54, v55
    v_cvt_pk_bf16_f32 v54, v56, v57
    v_cvt_pk_bf16_f32 v55, v58, v59
    v_cvt_pk_bf16_f32 v56, v60, v61
    v_cvt_pk_bf16_f32 v57, v62, v63
    v_cvt_pk_bf16_f32 v58, v64, v65
    v_cvt_pk_bf16_f32 v59, v66, v67
    buffer_store_dwordx4 v[52:55], v2, s[36:39], s47 offen offset:2048 sc1
    buffer_store_dwordx4 v[56:59], v2, s[36:39], s47 offen offset:3072 sc1
    v_mov_b32 v248, 1
    v_mov_b32 v249, 0
    s_waitcnt vmcnt(0)
    s_mov_b64 exec, 1
    buffer_atomic_add v248, v249, s[36:39], s69 offen sc1
    s_mov_b64 exec, -1
    v_mov_b32 v248, 161804
    v_mov_b32 v249, 1
    s_mov_b64 exec, 1
    ds_add_u32 v248, v249
    s_mov_b64 exec, -1
    s_mov_b32 s51, 0x400000
    v_mov_b32 v249, 161804
L_mk_c3d:
    ds_read_b32 v248, v249
    s_waitcnt lgkmcnt(0)
    s_sub_u32 s51, s51, 1
    v_readfirstlane_b32 s49, v248
    s_cmp_eq_u32 s51, 0
    s_cbranch_scc1 L_mk_c3dgo
    s_cmp_ge_u32 s49, 4
    s_cbranch_scc1 L_mk_c3dgo
    s_sleep 1
    s_branch L_mk_c3d
L_mk_c3dgo:
    s_mov_b32 m0, s54
    s_add_u32 s54, s54, 2128
    buffer_load_dwordx4 v2, s[36:39], s52 offen sc1 lds
    buffer_load_dwordx4 v2, s[36:39], s53 offen offset:1024 sc1 lds
    s_add_u32 s52, s52, 1024
    s_add_u32 s53, s53, 1024
    s_mov_b32 m0, s54
    s_add_u32 s54, s54, 2128
    buffer_load_dwordx4 v2, s[36:39], s52 offen sc1 lds
    buffer_load_dwordx4 v2, s[36:39], s53 offen offset:1024 sc1 lds
    s_add_u32 s52, s52, 1024
    s_add_u32 s53, s53, 1024
    s_mov_b32 m0, s54
    s_add_u32 s54, s54, 2128
    buffer_load_dwordx4 v2, s[36:39], s52 offen sc1 lds
    buffer_load_dwordx4 v2, s[36:39], s53 offen offset:1024 sc1 lds
    s_add_u32 s52, s52, 1024
    s_add_u32 s53, s53, 1024
    s_mov_b32 m0, s54
    s_add_u32 s54, s54, 2128
    buffer_load_dwordx4 v2, s[36:39], s52 offen sc1 lds
    buffer_load_dwordx4 v2, s[36:39], s53 offen offset:1024 sc1 lds
    s_add_u32 s3, s3, 4096
    s_cmp_eq_u32 s3, 28672
    s_cselect_b32 s3, 0, s3
    s_add_u32 s52, s44, s3
    s_add_u32 s53, s48, s3
    s_mov_b32 m0, s54
    s_add_u32 s54, s54, 2128
    buffer_load_dwordx4 v2, s[36:39], s52 offen sc1 lds
    buffer_load_dwordx4 v2, s[36:39], s53 offen offset:1024 sc1 lds
    s_add_u32 s52, s52, 1024
    s_add_u32 s53, s53, 1024
    s_mov_b32 m0, s54
    s_add_u32 s54, s54, 2128
    buffer_load_dwordx4 v2, s[36:39], s52 offen sc1 lds
    buffer_load_dwordx4 v2, s[36:39], s53 offen offset:1024 sc1 lds
    s_add_u32 s52, s52, 1024
    s_add_u32 s53, s53, 1024
    s_mov_b32 m0, s54
    s_add_u32 s54, s54, 2128
    buffer_load_dwordx4 v2, s[36:39], s52 offen sc1 lds
    buffer_load_dwordx4 v2, s[36:39], s53 offen offset:1024 sc1 lds
    s_add_u32 s52, s52, 1024
    s_add_u32 s53, s53, 1024
    s_mov_b32 m0, s54
    s_add_u32 s54, s54, 2128
    buffer_load_dwordx4 v2, s[36:39], s52 offen sc1 lds
    buffer_load_dwordx4 v2, s[36:39], s53 offen offset:1024 sc1 lds
    s_add_u32 s3, s3, 4096
    s_cmp_eq_u32 s3, 28672
    s_cselect_b32 s3, 0, s3
    s_add_u32 s52, s44, s3
    s_add_u32 s53, s48, s3
    s_branch L_mk_w4
L_mk_now3:
    s_setprio 0
    s_mov_b32 s51, 0x400000
    v_mov_b32 v252, 161760
L_mk_pwn:
    ds_read_b128 v[248:251], v252
    s_waitcnt lgkmcnt(0)
    v_min3_u32 v248, v248, v249, v250
    v_min_u32 v248, v248, v251
    s_sub_u32 s51, s51, 1
    v_readfirstlane_b32 s49, v248
    s_cmp_eq_u32 s51, 0
    s_cbranch_scc1 L_mk_pwngo
    s_cmp_ge_u32 s49, 24
    s_cbranch_scc1 L_mk_pwngo
    s_sleep 8
    s_branch L_mk_pwn
L_mk_pwngo:
    s_mov_b32 m0, s64
    s_and_b32 s16, s63, 0x1ffff
    s_add_u32 s16, s16, s59
    s_add_u32 s64, s64, 8512
    buffer_load_dwordx4 v2, s[36:39], s16 offen sc1 lds
    buffer_load_dwordx4 v2, s[36:39], s16 offen offset:1024 sc1 lds
    s_add_u32 s63, s63, 8192
    s_mov_b32 m0, s64
    s_and_b32 s16, s63, 0x1ffff
    s_add_u32 s16, s16, s59
    s_add_u32 s64, s64, 8512
    buffer_load_dwordx4 v2, s[36:39], s16 offen sc1 lds
    buffer_load_dwordx4 v2, s[36:39], s16 offen offset:1024 sc1 lds
    s_add_u32 s63, s63, 8192
    s_mov_b32 m0, s64
    s_and_b32 s16, s63, 0x1ffff
    s_add_u32 s16, s16, s59
    s_add_u32 s64, s64, 8512
    buffer_load_dwordx4 v2, s[36:39], s16 offen sc1 lds
    buffer_load_dwordx4 v2, s[36:39], s16 offen offset:1024 sc1 lds
    s_add_u32 s63, s63, 8192
    s_mov_b32 m0, s64
    s_and_b32 s16, s63, 0x1ffff
    s_add_u32 s16, s16, s59
    s_add_u32 s64, s64, 8512
    buffer_load_dwordx4 v2, s[36:39], s16 offen sc1 lds
    buffer_load_dwordx4 v2, s[36:39], s16 offen offset:1024 sc1 lds
    s_add_u32 s63, s63, 8192
    s_mov_b32 m0, s64
    s_and_b32 s16, s63, 0x1ffff
    s_add_u32 s16, s16, s59
    s_add_u32 s64, s64, 8512
    buffer_load_dwordx4 v2, s[36:39], s16 offen sc1 lds
    buffer_load_dwordx4 v2, s[36:39], s16 offen offset:1024 sc1 lds
    s_add_u32 s63, s63, 8192
    s_mov_b32 m0, s64
    s_and_b32 s16, s63, 0x1ffff
    s_add_u32 s16, s16, s59
    s_add_u32 s64, s64, 8512
    buffer_load_dwordx4 v2, s[36:39], s16 offen sc1 lds
    buffer_load_dwordx4 v2, s[36:39], s16 offen offset:1024 sc1 lds
    s_add_u32 s63, s63, 8192
    s_and_b32 s41, s2, 7
    s_lshl_b32 s41, s41, 2
    s_bfe_u32 s42, s2, 0x20003
    s_add_u32 s41, s41, s42
    s_lshr_b32 s42, s2, 5
    s_lshl_b32 s41, s41, 1
    s_lshl_b32 s42, s42, 1
    s_mul_i32 s43, s60, 28672
    s_mul_i32 s44, s42, 114688
    s_add_u32 s44, s44, s43
    s_add_u32 s44, s44, 0xb00000
    s_add_u32 s45, s44, 114688
    s_lshr_b32 s55, s2, 5
    s_bfe_u32 s43, s2, 0x20003
    s_lshl_b32 s43, s43, 1
    s_add_u32 s55, s55, s43
    s_and_b32 s55, s55, 15
    s_cmp_ge_u32 s55, 7
    s_cselect_b32 s43, 7, 0
    s_sub_u32 s55, s55, s43
    s_lshl_b32 s58, s55, 12
    s_add_u32 s56, s44, s58
    s_add_u32 s57, s45, s58
    buffer_load_dwordx4 v[96:99], v2, s[36:39], s56 offen offset:0 sc1
    buffer_load_dwordx4 v[100:103], v2, s[36:39], s57 offen offset:0 sc1
    buffer_load_dwordx4 v[104:107], v2, s[36:39], s56 offen offset:1024 sc1
    buffer_load_dwordx4 v[108:111], v2, s[36:39], s57 offen offset:1024 sc1
    buffer_load_dwordx4 v[112:115], v2, s[36:39], s56 offen offset:2048 sc1
    buffer_load_dwordx4 v[116:119], v2, s[36:39], s57 offen offset:2048 sc1
    buffer_load_dwordx4 v[120:123], v2, s[36:39], s56 offen offset:3072 sc1
    buffer_load_dwordx4 v[124:127], v2, s[36:39], s57 offen offset:3072 sc1
    s_add_u32 s58, s58, 4096
    s_cmp_eq_u32 s58, 28672
    s_cselect_b32 s58, 0, s58
    s_add_u32 s56, s44, s58
    s_add_u32 s57, s45, s58
    buffer_load_dwordx4 v[128:131], v2, s[36:39], s56 offen offset:0 sc1
    buffer_load_dwordx4 v[132:135], v2, s[36:39], s57 offen offset:0 sc1
    buffer_load_dwordx4 v[136:139], v2, s[36:39], s56 offen offset:1024 sc1
    buffer_load_dwordx4 v[140:143], v2, s[36:39], s57 offen offset:1024 sc1
    buffer_load_dwordx4 v[144:147], v2, s[36:39], s56 offen offset:2048 sc1
    buffer_load_dwordx4 v[148:151], v2, s[36:39], s57 offen offset:2048 sc1
    buffer_load_dwordx4 v[152:155], v2, s[36:39], s56 offen offset:3072 sc1
    buffer_load_dwordx4 v[156:159], v2, s[36:39], s57 offen offset:3072 sc1
    s_add_u32 s58, s58, 4096
    s_cmp_eq_u32 s58, 28672
    s_cselect_b32 s58, 0, s58
    s_add_u32 s56, s44, s58
    s_add_u32 s57, s45, s58
    s_waitcnt vmcnt(16)
    v_mov_b32 v248, s65
    v_mov_b32 v249, 7
    ds_write_b32 v248, v249
    s_mov_b32 s46, s48
    s_mul_i32 s54, s60, 17024
    s_add_u32 s54, s54, 85120
    v_add_u32 v88, s54, v2
    s_add_u32 s50, s55, 5
    s_cmp_ge_u32 s50, 7
    s_cselect_b32 s43, 7, 0
    s_sub_u32 s50, s50, s43
    s_sub_u32 s48, s45, 1024
    s_lshl_b32 s3, s50, 12
    s_add_u32 s52, s44, s3
    s_add_u32 s53, s48, s3
    s_mov_b32 s51, 0x400000
    v_mov_b32 v252, 161744
L_mk_pwn4:
    ds_read_b128 v[248:251], v252
    s_waitcnt lgkmcnt(0)
    v_min3_u32 v248, v248, v249, v250
    v_min_u32 v248, v248, v251
    s_sub_u32 s51, s51, 1
    v_readfirstlane_b32 s49, v248
    s_cmp_eq_u32 s51, 0
    s_cbranch_scc1 L_mk_pwn4go
    s_cmp_ge_u32 s49, 7
    s_cbranch_scc1 L_mk_pwn4go
    s_sleep 8
    s_branch L_mk_pwn4
L_mk_pwn4go:
    s_mov_b32 m0, s54
    s_add_u32 s54, s54, 2128
    buffer_load_dwordx4 v2, s[36:39], s52 offen sc1 lds
    buffer_load_dwordx4 v2, s[36:39], s53 offen offset:1024 sc1 lds
    s_add_u32 s52, s52, 1024
    s_add_u32 s53, s53, 1024
    s_mov_b32 m0, s54
    s_add_u32 s54, s54, 2128
    buffer_load_dwordx4 v2, s[36:39], s52 offen sc1 lds
    buffer_load_dwordx4 v2, s[36:39], s53 offen offset:1024 sc1 lds
    s_add_u32 s52, s52, 1024
    s_add_u32 s53, s53, 1024
    s_mov_b32 m0, s54
    s_add_u32 s54, s54, 2128
    buffer_load_dwordx4 v2, s[36:39], s52 offen sc1 lds
    buffer_load_dwordx4 v2, s[36:39], s53 offen offset:1024 sc1 lds
    s_add_u32 s52, s52, 1024
    s_add_u32 s53, s53, 1024
    s_mov_b32 m0, s54
    s_add_u32 s54, s54, 2128
    buffer_load_dwordx4 v2, s[36:39], s52 offen sc1 lds
    buffer_load_dwordx4 v2, s[36:39], s53 offen offset:1024 sc1 lds
    s_add_u32 s3, s3, 4096
    s_cmp_eq_u32 s3, 28672
    s_cselect_b32 s3, 0, s3
    s_add_u32 s52, s44, s3
    s_add_u32 s53, s48, s3
    s_mov_b32 m0, s54
    s_add_u32 s54, s54, 2128
    buffer_load_dwordx4 v2, s[36:39], s52 offen sc1 lds
    buffer_load_dwordx4 v2, s[36:39], s53 offen offset:1024 sc1 lds
    s_add_u32 s52, s52, 1024
    s_add_u32 s53, s53, 1024
    s_mov_b32 m0, s54
    s_add_u32 s54, s54, 2128
    buffer_load_dwordx4 v2, s[36:39], s52 offen sc1 lds
    buffer_load_dwordx4 v2, s[36:39], s53 offen offset:1024 sc1 lds
    s_add_u32 s52, s52, 1024
    s_add_u32 s53, s53, 1024
    s_mov_b32 m0, s54
    s_add_u32 s54, s54, 2128
    buffer_load_dwordx4 v2, s[36:39], s52 offen sc1 lds
    buffer_load_dwordx4 v2, s[36:39], s53 offen offset:1024 sc1 lds
    s_add_u32 s52, s52, 1024
    s_add_u32 s53, s53, 1024
    s_mov_b32 m0, s54
    s_add_u32 s54, s54, 2128
    buffer_load_dwordx4 v2, s[36:39], s52 offen sc1 lds
    buffer_load_dwordx4 v2, s[36:39], s53 offen offset:1024 sc1 lds
    s_add_u32 s3, s3, 4096
    s_cmp_eq_u32 s3, 28672
    s_cselect_b32 s3, 0, s3
    s_add_u32 s52, s44, s3
    s_add_u32 s53, s48, s3
    s_mov_b32 s51, 0x400000
    v_mov_b32 v252, 161760
L_mk_pwn5:
    ds_read_b128 v[248:251], v252
    s_waitcnt lgkmcnt(0)
    v_min3_u32 v248, v248, v249, v250
    v_min_u32 v248, v248, v251
    s_sub_u32 s51, s51, 1
    v_readfirstlane_b32 s49, v248
    s_cmp_eq_u32 s51, 0
    s_cbranch_scc1 L_mk_pwn5go
    s_cmp_ge_u32 s49, 48
    s_cbranch_scc1 L_mk_pwn5go
    s_sleep 16
    s_branch L_mk_pwn5
L_mk_pwn5go:
L_mk_w4:
    s_mul_i32 s43, s60, 28672
    s_mul_i32 s46, s41, 114688
    s_add_u32 s46, s46, s43
    s_add_u32 s46, s46, 0x1100000
    s_add_u32 s47, s46, 114688
    s_lshl_b32 s61, s41, 7
    s_add_u32 s61, s61, 0xd87000
    v_mov_b32 v85, 0
    v_and_b32 v84, 31, v1
    v_lshlrev_b32 v84, 4, v84
    v_lshrrev_b32 v86, 5, v1
    v_lshl_add_u32 v84, v86, 12, v84
    s_lshl_b32 s64, s55, 12
    s_add_u32 s62, s46, s64
    s_add_u32 s63, s47, s64
    s_mov_b32 s51, 0x40000
    s_cmp_lg_u32 s40, 4
    s_cbranch_scc1 L_mk_hpolll
    s_mov_b64 exec, 1
L_mk_hpoll:
    v_mov_b32 v160, 0
    buffer_atomic_add v160, v85, s[36:39], s61 offen sc0 sc1
    s_sub_u32 s51, s51, 1
    s_cmp_eq_u32 s51, 0
    s_waitcnt vmcnt(0)
    s_cbranch_scc1 L_mk_hpollset
    v_cmp_gt_u32 vcc, 28, v160
    s_nop 4
    s_cbranch_vccz L_mk_hpollset
    s_sleep 3
    s_branch L_mk_hpoll
L_mk_hpollset:
    s_mov_b64 exec, -1
    v_mov_b32 v160, 161780
    v_mov_b32 v161, 1
    ds_write_b32 v160, v161
    s_branch L_mk_hpollwgo
L_mk_hpolll:
    s_mov_b32 s51, 0x400000
    v_mov_b32 v161, 161780
L_mk_hpollw:
    ds_read_b32 v160, v161
    s_waitcnt lgkmcnt(0)
    s_sub_u32 s51, s51, 1
    v_readfirstlane_b32 s49, v160
    s_cmp_eq_u32 s51, 0
    s_cbranch_scc1 L_mk_hpollwgo
    s_cmp_ge_u32 s49, 1
    s_cbranch_scc1 L_mk_hpollwgo
    s_sleep 2
    s_branch L_mk_hpollw
L_mk_hpollwgo:
    s_setprio 0
    buffer_load_dwordx4 v[160:163], v2, s[36:39], s62 offen offset:0 sc1
    buffer_load_dwordx4 v[164:167], v2, s[36:39], s63 offen offset:0 sc1
    buffer_load_dwordx4 v[168:171], v2, s[36:39], s62 offen offset:1024 sc1
    buffer_load_dwordx4 v[172:175], v2, s[36:39], s63 offen offset:1024 sc1
    buffer_load_dwordx4 v[176:179], v2, s[36:39], s62 offen offset:2048 sc1
    buffer_load_dwordx4 v[180:183], v2, s[36:39], s63 offen offset:2048 sc1
    buffer_load_dwordx4 v[184:187], v2, s[36:39], s62 offen offset:3072 sc1
    buffer_load_dwordx4 v[188:191], v2, s[36:39], s63 offen offset:3072 sc1
    s_add_u32 s64, s64, 4096
    s_cmp_eq_u32 s64, 28672
    s_cselect_b32 s64, 0, s64
    s_add_u32 s62, s46, s64
    s_add_u32 s63, s47, s64
    buffer_load_dwordx4 v[192:195], v2, s[36:39], s62 offen offset:0 sc1
    buffer_load_dwordx4 v[196:199], v2, s[36:39], s63 offen offset:0 sc1
    s_lshl_b32 s43, s66, 13
    s_add_u32 s43, s43, 0x1000008
    s_lshl_b32 s50, s67, 15
    s_add_u32 s50, s50, 0x880000
    s_waitcnt vmcnt(8)
    v_mfma_f32_32x32x16_bf16 v[4:19], v[96:99], v[160:163], 0
    buffer_load_dwordx4 v[200:203], v2, s[36:39], s62 offen offset:1024 sc1
    v_mfma_f32_32x32x16_bf16 v[20:35], v[96:99], v[164:167], 0
    buffer_load_dwordx4 v[204:207], v2, s[36:39], s63 offen offset:1024 sc1
    v_mfma_f32_32x32x16_bf16 v[36:51], v[100:103], v[160:163], 0
    v_mfma_f32_32x32x16_bf16 v[52:67], v[100:103], v[164:167], 0
    s_waitcnt vmcnt(8)
    v_mfma_f32_32x32x16_bf16 v[4:19], v[104:107], v[168:171], v[4:19]
    buffer_load_dwordx4 v[208:211], v2, s[36:39], s62 offen offset:2048 sc1
    buffer_load_dwordx4 v[212:215], v2, s[36:39], s63 offen offset:2048 sc1
    v_mfma_f32_32x32x16_bf16 v[20:35], v[104:107], v[172:175], v[20:35]
    buffer_load_dwordx4 v[96:99], v2, s[36:39], s56 offen offset:0 sc1
    buffer_load_dwordx4 v[100:103], v2, s[36:39], s57 offen offset:0 sc1
    v_mfma_f32_32x32x16_bf16 v[36:51], v[108:111], v[168:171], v[36:51]
    v_mfma_f32_32x32x16_bf16 v[52:67], v[108:111], v[172:175], v[52:67]
    s_waitcnt vmcnt(10)
    v_mfma_f32_32x32x16_bf16 v[4:19], v[112:115], v[176:179], v[4:19]
    buffer_load_dwordx4 v[216:219], v2, s[36:39], s62 offen offset:3072 sc1
    buffer_load_dwordx4 v[220:223], v2, s[36:39], s63 offen offset:3072 sc1
    s_add_u32 s64, s64, 4096
    v_mfma_f32_32x32x16_bf16 v[20:35], v[112:115], v[180:183], v[20:35]
    s_cmp_eq_u32 s64, 28672
    s_cselect_b32 s64, 0, s64
    s_add_u32 s62, s46, s64
    v_mfma_f32_32x32x16_bf16 v[36:51], v[116:119], v[176:179], v[36:51]
    s_add_u32 s63, s47, s64
    buffer_load_dwordx4 v[104:107], v2, s[36:39], s56 offen offset:1024 sc1
    buffer_load_dwordx4 v[108:111], v2, s[36:39], s57 offen offset:1024 sc1
    v_mfma_f32_32x32x16_bf16 v[52:67], v[116:119], v[180:183], v[52:67]
    s_waitcnt vmcnt(12)
    v_mfma_f32_32x32x16_bf16 v[4:19], v[120:123], v[184:187], v[4:19]
    buffer_load_dwordx4 v[224:227], v2, s[36:39], s62 offen offset:0 sc1
    buffer_load_dwordx4 v[228:231], v2, s[36:39], s63 offen offset:0 sc1
    v_mfma_f32_32x32x16_bf16 v[20:35], v[120:123], v[188:191], v[20:35]
    buffer_load_dwordx4 v[112:115], v2, s[36:39], s56 offen offset:2048 sc1
    buffer_load_dwordx4 v[116:119], v2, s[36:39], s57 offen offset:2048 sc1
    v_mfma_f32_32x32x16_bf16 v[36:51], v[124:127], v[184:187], v[36:51]
    v_mfma_f32_32x32x16_bf16 v[52:67], v[124:127], v[188:191], v[52:67]
    s_waitcnt vmcnt(14)
    v_mfma_f32_32x32x16_bf16 v[4:19], v[128:131], v[192:195], v[4:19]
    buffer_load_dwordx4 v[232:235], v2, s[36:39], s62 offen offset:1024 sc1
    buffer_load_dwordx4 v[236:239], v2, s[36:39], s63 offen offset:1024 sc1
    buffer_load_dwordx4 v[120:123], v2, s[36:39], s56 offen offset:3072 sc1
    v_mfma_f32_32x32x16_bf16 v[20:35], v[128:131], v[196:199], v[20:35]
    buffer_load_dwordx4 v[124:127], v2, s[36:39], s57 offen offset:3072 sc1
    s_add_u32 s58, s58, 4096
    s_cmp_eq_u32 s58, 28672
    v_mfma_f32_32x32x16_bf16 v[36:51], v[132:135], v[192:195], v[36:51]
    s_cselect_b32 s58, 0, s58
    s_add_u32 s56, s44, s58
    s_add_u32 s57, s45, s58
    v_mfma_f32_32x32x16_bf16 v[52:67], v[132:135], v[196:199], v[52:67]
    s_waitcnt vmcnt(16)
    v_mfma_f32_32x32x16_bf16 v[4:19], v[136:139], v[200:203], v[4:19]
    buffer_load_dwordx4 v[160:163], v2, s[36:39], s62 offen offset:2048 sc1
    buffer_load_dwordx4 v[164:167], v2, s[36:39], s63 offen offset:2048 sc1
    v_mfma_f32_32x32x16_bf16 v[20:35], v[136:139], v[204:207], v[20:35]
    buffer_load_dwordx4 v[128:131], v2, s[36:39], s56 offen offset:0 sc1
    buffer_load_dwordx4 v[132:135], v2, s[36:39], s57 offen offset:0 sc1
    v_mfma_f32_32x32x16_bf16 v[36:51], v[140:143], v[200:203], v[36:51]
    v_mfma_f32_32x32x16_bf16 v[52:67], v[140:143], v[204:207], v[52:67]
    s_waitcnt vmcnt(18)
    v_mfma_f32_32x32x16_bf16 v[4:19], v[144:147], v[208:211], v[4:19]
    buffer_load_dwordx4 v[168:171], v2, s[36:39], s62 offen offset:3072 sc1
    buffer_load_dwordx4 v[172:175], v2, s[36:39], s63 offen offset:3072 sc1
    s_add_u32 s64, s64, 4096
    v_mfma_f32_32x32x16_bf16 v[20:35], v[144:147], v[212:215], v[20:35]
    s_cmp_eq_u32 s64, 28672
    s_cselect_b32 s64, 0, s64
    s_add_u32 s62, s46, s64
    v_mfma_f32_32x32x16_bf16 v[36:51], v[148:151], v[208:211], v[36:51]
    s_add_u32 s63, s47, s64
    buffer_load_dwordx4 v[136:139], v2, s[36:39], s56 offen offset:1024 sc1
    buffer_load_dwordx4 v[140:143], v2, s[36:39], s57 offen offset:1024 sc1
    v_mfma_f32_32x32x16_bf16 v[52:67], v[148:151], v[212:215], v[52:67]
    s_waitcnt vmcnt(18)
    v_mfma_f32_32x32x16_bf16 v[4:19], v[152:155], v[216:219], v[4:19]
    buffer_load_dwordx4 v[176:179], v2, s[36:39], s62 offen offset:0 sc1
    buffer_load_dwordx4 v[180:183], v2, s[36:39], s63 offen offset:0 sc1
    v_mfma_f32_32x32x16_bf16 v[20:35], v[152:155], v[220:223], v[20:35]
    buffer_load_dwordx4 v[144:147], v2, s[36:39], s56 offen offset:2048 sc1
    buffer_load_dwordx4 v[148:151], v2, s[36:39], s57 offen offset:2048 sc1
    v_mfma_f32_32x32x16_bf16 v[36:51], v[156:159], v[216:219], v[36:51]
    v_mfma_f32_32x32x16_bf16 v[52:67], v[156:159], v[220:223], v[52:67]
    s_waitcnt vmcnt(18)
    v_mfma_f32_32x32x16_bf16 v[4:19], v[96:99], v[224:227], v[4:19]
    buffer_load_dwordx4 v[184:187], v2, s[36:39], s62 offen offset:1024 sc1
    buffer_load_dwordx4 v[188:191], v2, s[36:39], s63 offen offset:1024 sc1
    buffer_load_dwordx4 v[192:195], v2, s[36:39], s62 offen offset:2048 sc1
    buffer_load_dwordx4 v[196:199], v2, s[36:39], s63 offen offset:2048 sc1
    v_mfma_f32_32x32x16_bf16 v[20:35], v[96:99], v[228:231], v[20:35]
    buffer_load_dwordx4 v[152:155], v2, s[36:39], s56 offen offset:3072 sc1
    buffer_load_dwordx4 v[156:159], v2, s[36:39], s57 offen offset:3072 sc1
    s_add_u32 s58, s58, 4096
    s_cmp_eq_u32 s58, 28672
    v_mfma_f32_32x32x16_bf16 v[36:51], v[100:103], v[224:227], v[36:51]
    s_cselect_b32 s58, 0, s58
    s_add_u32 s56, s44, s58
    s_add_u32 s57, s45, s58
    v_mfma_f32_32x32x16_bf16 v[52:67], v[100:103], v[228:231], v[52:67]
    s_waitcnt vmcnt(20)
    v_mfma_f32_32x32x16_bf16 v[4:19], v[104:107], v[232:235], v[4:19]
    buffer_load_dwordx4 v[200:203], v2, s[36:39], s62 offen offset:3072 sc1
    buffer_load_dwordx4 v[204:207], v2, s[36:39], s63 offen offset:3072 sc1
    s_add_u32 s64, s64, 4096
    s_cmp_eq_u32 s64, 28672
    v_mfma_f32_32x32x16_bf16 v[20:35], v[104:107], v[236:239], v[20:35]
    s_cselect_b32 s64, 0, s64
    s_add_u32 s62, s46, s64
    s_add_u32 s63, s47, s64
    buffer_load_dwordx4 v[208:211], v2, s[36:39], s62 offen offset:0 sc1
    v_mfma_f32_32x32x16_bf16 v[36:51], v[108:111], v[232:235], v[36:51]
    buffer_load_dwordx4 v[212:215], v2, s[36:39], s63 offen offset:0 sc1
    buffer_load_dwordx4 v[96:99], v2, s[36:39], s56 offen offset:0 sc1
    buffer_load_dwordx4 v[100:103], v2, s[36:39], s57 offen offset:0 sc1
    v_mfma_f32_32x32x16_bf16 v[52:67], v[108:111], v[236:239], v[52:67]
    s_waitcnt vmcnt(22)
    v_mfma_f32_32x32x16_bf16 v[4:19], v[112:115], v[160:163], v[4:19]
    buffer_load_dwordx4 v[216:219], v2, s[36:39], s62 offen offset:1024 sc1
    buffer_load_dwordx4 v[220:223], v2, s[36:39], s63 offen offset:1024 sc1
    v_mfma_f32_32x32x16_bf16 v[20:35], v[112:115], v[164:167], v[20:35]
    buffer_load_dwordx4 v[224:227], v2, s[36:39], s62 offen offset:2048 sc1
    buffer_load_dwordx4 v[228:231], v2, s[36:39], s63 offen offset:2048 sc1
    v_mfma_f32_32x32x16_bf16 v[36:51], v[116:119], v[160:163], v[36:51]
    buffer_load_dwordx4 v[104:107], v2, s[36:39], s56 offen offset:1024 sc1
    buffer_load_dwordx4 v[108:111], v2, s[36:39], s57 offen offset:1024 sc1
    v_mfma_f32_32x32x16_bf16 v[52:67], v[116:119], v[164:167], v[52:67]
    s_waitcnt vmcnt(24)
    v_mfma_f32_32x32x16_bf16 v[4:19], v[120:123], v[168:171], v[4:19]
    buffer_load_dwordx4 v[232:235], v2, s[36:39], s62 offen offset:3072 sc1
    buffer_load_dwordx4 v[236:239], v2, s[36:39], s63 offen offset:3072 sc1
    s_add_u32 s64, s64, 4096
    s_cmp_eq_u32 s64, 28672
    v_mfma_f32_32x32x16_bf16 v[20:35], v[120:123], v[172:175], v[20:35]
    s_cselect_b32 s64, 0, s64
    s_add_u32 s62, s46, s64
    s_add_u32 s63, s47, s64
    buffer_load_dwordx4 v[160:163], v2, s[36:39], s62 offen offset:0 sc1
    v_mfma_f32_32x32x16_bf16 v[36:51], v[124:127], v[168:171], v[36:51]
    buffer_load_dwordx4 v[164:167], v2, s[36:39], s63 offen offset:0 sc1
    buffer_load_dwordx4 v[112:115], v2, s[36:39], s56 offen offset:2048 sc1
    buffer_load_dwordx4 v[116:119], v2, s[36:39], s57 offen offset:2048 sc1
    v_mfma_f32_32x32x16_bf16 v[52:67], v[124:127], v[172:175], v[52:67]
    s_waitcnt vmcnt(26)
    v_mfma_f32_32x32x16_bf16 v[4:19], v[128:131], v[176:179], v[4:19]
    buffer_load_dwordx4 v[168:171], v2, s[36:39], s62 offen offset:1024 sc1
    buffer_load_dwordx4 v[172:175], v2, s[36:39], s63 offen offset:1024 sc1
    buffer_load_dwordx4 v[120:123], v2, s[36:39], s56 offen offset:3072 sc1
    v_mfma_f32_32x32x16_bf16 v[20:35], v[128:131], v[180:183], v[20:35]
    buffer_load_dwordx4 v[124:127], v2, s[36:39], s57 offen offset:3072 sc1
    s_add_u32 s58, s58, 4096
    s_cmp_eq_u32 s58, 28672
    v_mfma_f32_32x32x16_bf16 v[36:51], v[132:135], v[176:179], v[36:51]
    s_cselect_b32 s58, 0, s58
    s_add_u32 s56, s44, s58
    s_add_u32 s57, s45, s58
    v_mfma_f32_32x32x16_bf16 v[52:67], v[132:135], v[180:183], v[52:67]
    s_waitcnt vmcnt(26)
    v_mfma_f32_32x32x16_bf16 v[4:19], v[136:139], v[184:187], v[4:19]
    buffer_load_dwordx4 v[176:179], v2, s[36:39], s62 offen offset:2048 sc1
    buffer_load_dwordx4 v[180:183], v2, s[36:39], s63 offen offset:2048 sc1
    buffer_load_dwordx4 v[68:71], v2, s[36:39], s68 offen sc1
    buffer_load_dwordx4 v[72:75], v2, s[36:39], s68 offen offset:1024 sc1
    v_mfma_f32_32x32x16_bf16 v[20:35], v[136:139], v[188:191], v[20:35]
    buffer_load_dword v76, v84, s[36:39], s43 offen offset:0 sc1
    buffer_load_dword v77, v84, s[36:39], s43 offen offset:512 sc1
    buffer_load_dword v78, v84, s[36:39], s43 offen offset:1024 sc1
    buffer_load_dword v79, v84, s[36:39], s43 offen offset:1536 sc1
    v_mfma_f32_32x32x16_bf16 v[36:51], v[140:143], v[184:187], v[36:51]
    buffer_load_dword v80, v84, s[36:39], s43 offen offset:2048 sc1
    buffer_load_dword v81, v84, s[36:39], s43 offen offset:2560 sc1
    buffer_load_dword v82, v84, s[36:39], s43 offen offset:3072 sc1
    buffer_load_dword v83, v84, s[36:39], s43 offen offset:3584 sc1
    v_mfma_f32_32x32x16_bf16 v[52:67], v[140:143], v[188:191], v[52:67]
    s_waitcnt vmcnt(36)
    v_mfma_f32_32x32x16_bf16 v[4:19], v[144:147], v[192:195], v[4:19]
    buffer_load_dwordx4 v[184:187], v2, s[36:39], s62 offen offset:3072 sc1
    buffer_load_dwordx4 v[188:191], v2, s[36:39], s63 offen offset:3072 sc1
    s_add_u32 s64, s64, 4096
    v_mfma_f32_32x32x16_bf16 v[20:35], v[144:147], v[196:199], v[20:35]
    s_cmp_eq_u32 s64, 28672
    s_cselect_b32 s64, 0, s64
    s_add_u32 s62, s46, s64
    v_mfma_f32_32x32x16_bf16 v[36:51], v[148:151], v[192:195], v[36:51]
    s_add_u32 s63, s47, s64
    v_mfma_f32_32x32x16_bf16 v[52:67], v[148:151], v[196:199], v[52:67]
    s_waitcnt vmcnt(34)
    v_mfma_f32_32x32x16_bf16 v[4:19], v[152:155], v[200:203], v[4:19]
    buffer_load_dwordx4 v[192:195], v2, s[36:39], s62 offen offset:0 sc1
    v_mfma_f32_32x32x16_bf16 v[20:35], v[152:155], v[204:207], v[20:35]
    buffer_load_dwordx4 v[196:199], v2, s[36:39], s63 offen offset:0 sc1
    v_mfma_f32_32x32x16_bf16 v[36:51], v[156:159], v[200:203], v[36:51]
    v_mfma_f32_32x32x16_bf16 v[52:67], v[156:159], v[204:207], v[52:67]
    s_waitcnt vmcnt(32)
    v_mfma_f32_32x32x16_bf16 v[4:19], v[96:99], v[208:211], v[4:19]
    buffer_load_dwordx4 v[200:203], v2, s[36:39], s62 offen offset:1024 sc1
    v_mfma_f32_32x32x16_bf16 v[20:35], v[96:99], v[212:215], v[20:35]
    buffer_load_dwordx4 v[204:207], v2, s[36:39], s63 offen offset:1024 sc1
    v_mfma_f32_32x32x16_bf16 v[36:51], v[100:103], v[208:211], v[36:51]
    v_mfma_f32_32x32x16_bf16 v[52:67], v[100:103], v[212:215], v[52:67]
    v_mov_b32 v89, 161828
    v_mov_b32 v90, 1
    s_mov_b64 exec, 1
    ds_add_u32 v89, v90
    s_mov_b64 exec, -1
    s_waitcnt vmcnt(28)
    v_mfma_f32_32x32x16_bf16 v[4:19], v[104:107], v[216:219], v[4:19]
    buffer_load_dwordx4 v[208:211], v2, s[36:39], s62 offen offset:2048 sc1
    v_mfma_f32_32x32x16_bf16 v[20:35], v[104:107], v[220:223], v[20:35]
    buffer_load_dwordx4 v[212:215], v2, s[36:39], s63 offen offset:2048 sc1
    v_mfma_f32_32x32x16_bf16 v[36:51], v[108:111], v[216:219], v[36:51]
    v_mfma_f32_32x32x16_bf16 v[52:67], v[108:111], v[220:223], v[52:67]
    s_waitcnt vmcnt(24)
    v_mfma_f32_32x32x16_bf16 v[4:19], v[112:115], v[224:227], v[4:19]
    buffer_load_dwordx4 v[216:219], v2, s[36:39], s62 offen offset:3072 sc1
    buffer_load_dwordx4 v[220:223], v2, s[36:39], s63 offen offset:3072 sc1
    s_add_u32 s64, s64, 4096
    v_mfma_f32_32x32x16_bf16 v[20:35], v[112:115], v[228:231], v[20:35]
    s_cmp_eq_u32 s64, 28672
    s_cselect_b32 s64, 0, s64
    s_add_u32 s62, s46, s64
    v_mfma_f32_32x32x16_bf16 v[36:51], v[116:119], v[224:227], v[36:51]
    s_add_u32 s63, s47, s64
    v_mfma_f32_32x32x16_bf16 v[52:67], v[116:119], v[228:231], v[52:67]
    s_waitcnt vmcnt(22)
    v_mfma_f32_32x32x16_bf16 v[4:19], v[120:123], v[232:235], v[4:19]
    ds_read_b128 v[240:243], v88 offset:0
    v_mfma_f32_32x32x16_bf16 v[20:35], v[120:123], v[236:239], v[20:35]
    ds_read_b128 v[244:247], v88 offset:1024
    v_mfma_f32_32x32x16_bf16 v[36:51], v[124:127], v[232:235], v[36:51]
    v_mfma_f32_32x32x16_bf16 v[52:67], v[124:127], v[236:239], v[52:67]
    s_waitcnt vmcnt(22) lgkmcnt(0)
    v_mfma_f32_32x32x16_bf16 v[4:19], v[240:243], v[160:163], v[4:19]
    ds_read_b128 v[248:251], v88 offset:2128
    v_mfma_f32_32x32x16_bf16 v[20:35], v[240:243], v[164:167], v[20:35]
    ds_read_b128 v[252:255], v88 offset:3152
    v_mfma_f32_32x32x16_bf16 v[36:51], v[244:247], v[160:163], v[36:51]
    v_mfma_f32_32x32x16_bf16 v[52:67], v[244:247], v[164:167], v[52:67]
    s_waitcnt vmcnt(22) lgkmcnt(0)
    v_mfma_f32_32x32x16_bf16 v[4:19], v[248:251], v[168:171], v[4:19]
    ds_read_b128 v[240:243], v88 offset:4256
    v_mfma_f32_32x32x16_bf16 v[20:35], v[248:251], v[172:175], v[20:35]
    ds_read_b128 v[244:247], v88 offset:5280
    v_mfma_f32_32x32x16_bf16 v[36:51], v[252:255], v[168:171], v[36:51]
    v_mfma_f32_32x32x16_bf16 v[52:67], v[252:255], v[172:175], v[52:67]
    s_waitcnt vmcnt(20) lgkmcnt(0)
    v_mfma_f32_32x32x16_bf16 v[4:19], v[240:243], v[176:179], v[4:19]
    ds_read_b128 v[248:251], v88 offset:6384
    v_mfma_f32_32x32x16_bf16 v[20:35], v[240:243], v[180:183], v[20:35]
    ds_read_b128 v[252:255], v88 offset:7408
    v_mfma_f32_32x32x16_bf16 v[36:51], v[244:247], v[176:179], v[36:51]
    v_mfma_f32_32x32x16_bf16 v[52:67], v[244:247], v[180:183], v[52:67]
    s_waitcnt vmcnt(8) lgkmcnt(0)
    v_mfma_f32_32x32x16_bf16 v[4:19], v[248:251], v[184:187], v[4:19]
    ds_read_b128 v[240:243], v88 offset:8512
    v_mfma_f32_32x32x16_bf16 v[20:35], v[248:251], v[188:191], v[20:35]
    ds_read_b128 v[244:247], v88 offset:9536
    v_mfma_f32_32x32x16_bf16 v[36:51], v[252:255], v[184:187], v[36:51]
    v_mfma_f32_32x32x16_bf16 v[52:67], v[252:255], v[188:191], v[52:67]
    s_waitcnt vmcnt(6) lgkmcnt(0)
    v_mfma_f32_32x32x16_bf16 v[4:19], v[240:243], v[192:195], v[4:19]
    ds_read_b128 v[248:251], v88 offset:10640
    v_mfma_f32_32x32x16_bf16 v[20:35], v[240:243], v[196:199], v[20:35]
    ds_read_b128 v[252:255], v88 offset:11664
    v_mfma_f32_32x32x16_bf16 v[36:51], v[244:247], v[192:195], v[36:51]
    v_mfma_f32_32x32x16_bf16 v[52:67], v[244:247], v[196:199], v[52:67]
    s_waitcnt vmcnt(4) lgkmcnt(0)
    v_mfma_f32_32x32x16_bf16 v[4:19], v[248:251], v[200:203], v[4:19]
    ds_read_b128 v[240:243], v88 offset:12768
    v_mfma_f32_32x32x16_bf16 v[20:35], v[248:251], v[204:207], v[20:35]
    ds_read_b128 v[244:247], v88 offset:13792
    v_mfma_f32_32x32x16_bf16 v[36:51], v[252:255], v[200:203], v[36:51]
    v_mfma_f32_32x32x16_bf16 v[52:67], v[252:255], v[204:207], v[52:67]
    s_waitcnt vmcnt(2) lgkmcnt(0)
    v_mfma_f32_32x32x16_bf16 v[4:19], v[240:243], v[208:211], v[4:19]
    ds_read_b128 v[248:251], v88 offset:14896
    v_mfma_f32_32x32x16_bf16 v[20:35], v[240:243], v[212:215], v[20:35]
    ds_read_b128 v[252:255], v88 offset:15920
    v_mfma_f32_32x32x16_bf16 v[36:51], v[244:247], v[208:211], v[36:51]
    v_mfma_f32_32x32x16_bf16 v[52:67], v[244:247], v[212:215], v[52:67]
    s_waitcnt vmcnt(0) lgkmcnt(0)
    v_mfma_f32_32x32x16_bf16 v[4:19], v[248:251], v[216:219], v[4:19]
    v_mfma_f32_32x32x16_bf16 v[20:35], v[248:251], v[220:223], v[20:35]
    v_mfma_f32_32x32x16_bf16 v[36:51], v[252:255], v[216:219], v[36:51]
    v_mfma_f32_32x32x16_bf16 v[52:67], v[252:255], v[220:223], v[52:67]
    s_setprio 2
    s_cmp_eq_u32 s60, 1
    s_cbranch_scc1 L_mk_q1
    s_cmp_eq_u32 s60, 2
    s_cbranch_scc1 L_mk_q2
    s_cmp_eq_u32 s60, 3
    s_cbranch_scc1 L_mk_q3
    s_nop 2
    ds_write_b128 v88, v[20:23] offset:0
    ds_write_b128 v88, v[24:27] offset:1024
    ds_write_b128 v88, v[28:31] offset:2128
    ds_write_b128 v88, v[32:35] offset:3152
    ds_write_b128 v88, v[36:39] offset:4256
    ds_write_b128 v88, v[40:43] offset:5280
    ds_write_b128 v88, v[44:47] offset:6384
    ds_write_b128 v88, v[48:51] offset:7408
    ds_write_b128 v88, v[52:55] offset:8512
    ds_write_b128 v88, v[56:59] offset:9536
    ds_write_b128 v88, v[60:63] offset:10640
    ds_write_b128 v88, v[64:67] offset:11664
    s_branch L_mk_qj
L_mk_q1:
    s_nop 5
    ds_write_b128 v88, v[4:7] offset:8512
    ds_write_b128 v88, v[8:11] offset:9536
    ds_write_b128 v88, v[12:15] offset:10640
    ds_write_b128 v88, v[16:19] offset:11664
    ds_write_b128 v88, v[36:39] offset:0
    ds_write_b128 v88, v[40:43] offset:1024
    ds_write_b128 v88, v[44:47] offset:2128
    ds_write_b128 v88, v[48:51] offset:3152
    ds_write_b128 v88, v[52:55] offset:4256
    ds_write_b128 v88, v[56:59] offset:5280
    ds_write_b128 v88, v[60:63] offset:6384
    ds_write_b128 v88, v[64:67] offset:7408
    v_pk_mov_b32 v[4:5], v[20:21], v[20:21] op_sel:[0,1]
    v_pk_mov_b32 v[6:7], v[22:23], v[22:23] op_sel:[0,1]
    v_pk_mov_b32 v[8:9], v[24:25], v[24:25] op_sel:[0,1]
    v_pk_mov_b32 v[10:11], v[26:27], v[26:27] op_sel:[0,1]
    v_pk_mov_b32 v[12:13], v[28:29], v[28:29] op_sel:[0,1]
    v_pk_mov_b32 v[14:15], v[30:31], v[30:31] op_sel:[0,1]
    v_pk_mov_b32 v[16:17], v[32:33], v[32:33] op_sel:[0,1]
    v_pk_mov_b32 v[18:19], v[34:35], v[34:35] op_sel:[0,1]
    s_branch L_mk_qj
L_mk_q2:
    s_nop 3
    ds_write_b128 v88, v[4:7] offset:4256
    ds_write_b128 v88, v[8:11] offset:5280
    ds_write_b128 v88, v[12:15] offset:6384
    ds_write_b128 v88, v[16:19] offset:7408
    ds_write_b128 v88, v[20:23] offset:8512
    ds_write_b128 v88, v[24:27] offset:9536
    ds_write_b128 v88, v[28:31] offset:10640
    ds_write_b128 v88, v[32:35] offset:11664
    ds_write_b128 v88, v[52:55] offset:0
    ds_write_b128 v88, v[56:59] offset:1024
    ds_write_b128 v88, v[60:63] offset:2128
    ds_write_b128 v88, v[64:67] offset:3152
    v_pk_mov_b32 v[4:5], v[36:37], v[36:37] op_sel:[0,1]
    v_pk_mov_b32 v[6:7], v[38:39], v[38:39] op_sel:[0,1]
    v_pk_mov_b32 v[8:9], v[40:41], v[40:41] op_sel:[0,1]
    v_pk_mov_b32 v[10:11], v[42:43], v[42:43] op_sel:[0,1]
    v_pk_mov_b32 v[12:13], v[44:45], v[44:45] op_sel:[0,1]
    v_pk_mov_b32 v[14:15], v[46:47], v[46:47] op_sel:[0,1]
    v_pk_mov_b32 v[16:17], v[48:49], v[48:49] op_sel:[0,1]
    v_pk_mov_b32 v[18:19], v[50:51], v[50:51] op_sel:[0,1]
    s_branch L_mk_qj
L_mk_q3:
    s_nop 1
    ds_write_b128 v88, v[4:7] offset:0
    ds_write_b128 v88, v[8:11] offset:1024
    ds_write_b128 v88, v[12:15] offset:2128
    ds_write_b128 v88, v[16:19] offset:3152
    ds_write_b128 v88, v[20:23] offset:4256
    ds_write_b128 v88, v[24:27] offset:5280
    ds_write_b128 v88, v[28:31] offset:6384
    ds_write_b128 v88, v[32:35] offset:7408
    ds_write_b128 v88, v[36:39] offset:8512
    ds_write_b128 v88, v[40:43] offset:9536
    ds_write_b128 v88, v[44:47] offset:10640
    ds_write_b128 v88, v[48:51] offset:11664
    v_pk_mov_b32 v[4:5], v[52:53], v[52:53] op_sel:[0,1]
    v_pk_mov_b32 v[6:7], v[54:55], v[54:55] op_sel:[0,1]
    v_pk_mov_b32 v[8:9], v[56:57], v[56:57] op_sel:[0,1]
    v_pk_mov_b32 v[10:11], v[58:59], v[58:59] op_sel:[0,1]
    v_pk_mov_b32 v[12:13], v[60:61], v[60:61] op_sel:[0,1]
    v_pk_mov_b32 v[14:15], v[62:63], v[62:63] op_sel:[0,1]
    v_pk_mov_b32 v[16:17], v[64:65], v[64:65] op_sel:[0,1]
    v_pk_mov_b32 v[18:19], v[66:67], v[66:67] op_sel:[0,1]
L_mk_qj:
    s_waitcnt lgkmcnt(0)
    v_mov_b32 v248, 161808
    v_mov_b32 v249, 1
    s_mov_b64 exec, 1
    ds_add_u32 v248, v249
    s_mov_b64 exec, -1
    v_pk_add_f32 v[76:77], v[76:77], v[80:81]
    v_pk_add_f32 v[78:79], v[78:79], v[82:83]
    v_pk_add_f32 v[76:77], v[76:77], v[78:79]
    v_add_f32 v76, v76, v77
    v_mov_b32 v77, v76
    s_nop 1
    v_permlane32_swap_b32 v77, v76
    s_nop 1
    v_add_f32 v76, v76, v77
    v_mul_f32 v76, 0xbfb8aa3b, v76
    v_exp_f32 v76, v76
    s_nop 0
    v_add_f32 v76, 1.0, v76
    v_rcp_f32 v76, v76
    s_nop 0
    v_sub_f32 v78, 1.0, v76
    v_lshlrev_b32 v224, 16, v68
    v_and_b32 v225, 0xffff0000, v68
    v_lshlrev_b32 v226, 16, v69
    v_and_b32 v227, 0xffff0000, v69
    v_lshlrev_b32 v228, 16, v70
    v_and_b32 v229, 0xffff0000, v70
    v_lshlrev_b32 v230, 16, v71
    v_and_b32 v231, 0xffff0000, v71
    v_lshlrev_b32 v232, 16, v72
    v_and_b32 v233, 0xffff0000, v72
    v_lshlrev_b32 v234, 16, v73
    v_and_b32 v235, 0xffff0000, v73
    v_lshlrev_b32 v236, 16, v74
    v_and_b32 v237, 0xffff0000, v74
    v_lshlrev_b32 v238, 16, v75
    v_and_b32 v239, 0xffff0000, v75
    v_pk_add_f32 v[224:225], v[224:225], v[4:5]
    v_pk_add_f32 v[226:227], v[226:227], v[6:7]
    v_pk_add_f32 v[228:229], v[228:229], v[8:9]
    v_pk_add_f32 v[230:231], v[230:231], v[10:11]
    v_pk_add_f32 v[232:233], v[232:233], v[12:13]
    v_pk_add_f32 v[234:235], v[234:235], v[14:15]
    v_pk_add_f32 v[236:237], v[236:237], v[16:17]
    v_pk_add_f32 v[238:239], v[238:239], v[18:19]
    s_lshl_b32 s44, s66, 15
    s_add_u32 s44, s44, 0x1800000
    s_lshl_b32 s61, s41, 6
    s_add_u32 s61, s61, 0xd82000
    v_and_b32 v85, 31, v1
    v_lshlrev_b32 v85, 2, v85
    s_sub_u32 s43, s60, 1
    s_and_b32 s43, s43, 3
    s_mul_i32 s43, s43, 17024
    s_add_u32 s43, s43, 85120
    v_add_u32 v89, s43, v2
    s_sub_u32 s43, s60, 2
    s_and_b32 s43, s43, 3
    s_mul_i32 s43, s43, 17024
    s_add_u32 s43, s43, 89376
    v_add_u32 v90, s43, v2
    s_sub_u32 s43, s60, 3
    s_and_b32 s43, s43, 3
    s_mul_i32 s43, s43, 17024
    s_add_u32 s43, s43, 93632
    v_add_u32 v91, s43, v2
    s_mov_b32 s51, 0x400000
    v_mov_b32 v249, 161808
L_mk_c4:
    ds_read_b32 v248, v249
    s_waitcnt lgkmcnt(0)
    s_sub_u32 s51, s51, 1
    v_readfirstlane_b32 s49, v248
    s_cmp_eq_u32 s51, 0
    s_cbranch_scc1 L_mk_c4go
    s_cmp_ge_u32 s49, 4
    s_cbranch_scc1 L_mk_c4go
    s_sleep 1
    s_branch L_mk_c4
L_mk_c4go:
    ds_read_b128 v[20:23], v89 offset:0
    ds_read_b128 v[24:27], v89 offset:1024
    ds_read_b128 v[28:31], v89 offset:2128
    ds_read_b128 v[32:35], v89 offset:3152
    ds_read_b128 v[36:39], v90 offset:0
    ds_read_b128 v[40:43], v90 offset:1024
    ds_read_b128 v[44:47], v90 offset:2128
    ds_read_b128 v[48:51], v90 offset:3152
    ds_read_b128 v[52:55], v91 offset:0
    ds_read_b128 v[56:59], v91 offset:1024
    ds_read_b128 v[60:63], v91 offset:2128
    ds_read_b128 v[64:67], v91 offset:3152
    s_mov_b32 s28, s22
    s_mov_b32 s29, s23
    s_mov_b32 s30, 0x200000
    s_mov_b32 s31, 0x00020000
    s_waitcnt lgkmcnt(4)
    v_pk_add_f32 v[20:21], v[20:21], v[36:37]
    v_pk_add_f32 v[22:23], v[22:23], v[38:39]
    v_pk_add_f32 v[24:25], v[24:25], v[40:41]
    v_pk_add_f32 v[26:27], v[26:27], v[42:43]
    v_pk_add_f32 v[28:29], v[28:29], v[44:45]
    v_pk_add_f32 v[30:31], v[30:31], v[46:47]
    v_pk_add_f32 v[32:33], v[32:33], v[48:49]
    v_pk_add_f32 v[34:35], v[34:35], v[50:51]
    v_pk_add_f32 v[224:225], v[224:225], v[20:21]
    v_pk_add_f32 v[226:227], v[226:227], v[22:23]
    v_pk_add_f32 v[228:229], v[228:229], v[24:25]
    v_pk_add_f32 v[230:231], v[230:231], v[26:27]
    v_pk_add_f32 v[232:233], v[232:233], v[28:29]
    v_pk_add_f32 v[234:235], v[234:235], v[30:31]
    v_pk_add_f32 v[236:237], v[236:237], v[32:33]
    v_pk_add_f32 v[238:239], v[238:239], v[34:35]
    s_waitcnt lgkmcnt(0)
    v_pk_add_f32 v[224:225], v[224:225], v[52:53]
    v_pk_add_f32 v[226:227], v[226:227], v[54:55]
    v_pk_add_f32 v[228:229], v[228:229], v[56:57]
    v_pk_add_f32 v[230:231], v[230:231], v[58:59]
    v_pk_add_f32 v[232:233], v[232:233], v[60:61]
    v_pk_add_f32 v[234:235], v[234:235], v[62:63]
    v_pk_add_f32 v[236:237], v[236:237], v[64:65]
    v_pk_add_f32 v[238:239], v[238:239], v[66:67]
    v_pk_mul_f32 v[224:225], v[224:225], v[78:79] op_sel_hi:[1,0]
    v_pk_mul_f32 v[226:227], v[226:227], v[78:79] op_sel_hi:[1,0]
    v_pk_mul_f32 v[228:229], v[228:229], v[78:79] op_sel_hi:[1,0]
    v_pk_mul_f32 v[230:231], v[230:231], v[78:79] op_sel_hi:[1,0]
    v_pk_mul_f32 v[232:233], v[232:233], v[78:79] op_sel_hi:[1,0]
    v_pk_mul_f32 v[234:235], v[234:235], v[78:79] op_sel_hi:[1,0]
    v_pk_mul_f32 v[236:237], v[236:237], v[78:79] op_sel_hi:[1,0]
    v_pk_mul_f32 v[238:239], v[238:239], v[78:79] op_sel_hi:[1,0]
    v_and_b32 v84, 31, v1
    v_lshlrev_b32 v84, 10, v84
    v_lshrrev_b32 v86, 5, v1
    v_lshl_add_u32 v84, v86, 4, v84
    s_lshl_b32 s52, s66, 15
    s_lshl_b32 s53, s67, 6
    s_add_u32 s52, s52, s53
    s_mul_i32 s43, s60, 17024
    v_add_u32 v85, s43, v2
    s_mov_b32 s51, 0x400000
    v_mov_b32 v249, 161824
L_mk_aw:
    ds_read_b32 v248, v249
    s_waitcnt lgkmcnt(0)
    s_sub_u32 s51, s51, 1
    v_readfirstlane_b32 s49, v248
    s_cmp_eq_u32 s51, 0
    s_cbranch_scc1 L_mk_awgo
    s_cmp_ge_u32 s49, 4
    s_cbranch_scc1 L_mk_awgo
    s_sleep 1
    s_branch L_mk_aw
L_mk_awgo:
    ds_read_b128 v[4:7], v85 offset:0
    ds_read_b128 v[8:11], v85 offset:1024
    ds_read_b128 v[12:15], v85 offset:2128
    ds_read_b128 v[16:19], v85 offset:3152
    ds_read_b128 v[20:23], v85 offset:4256
    ds_read_b128 v[24:27], v85 offset:5280
    ds_read_b128 v[28:31], v85 offset:6384
    ds_read_b128 v[32:35], v85 offset:7408
    ds_read_b128 v[36:39], v85 offset:8512
    ds_read_b128 v[40:43], v85 offset:9536
    ds_read_b128 v[44:47], v85 offset:10640
    ds_read_b128 v[48:51], v85 offset:11664
    ds_read_b128 v[52:55], v85 offset:12768
    ds_read_b128 v[56:59], v85 offset:13792
    s_waitcnt lgkmcnt(6)
    ds_read_b128 v[60:63], v85 offset:14896
    ds_read_b128 v[64:67], v85 offset:15920
    v_pk_add_f32 v[4:5], v[4:5], v[20:21]
    v_pk_add_f32 v[6:7], v[6:7], v[22:23]
    v_pk_add_f32 v[8:9], v[8:9], v[24:25]
    v_pk_add_f32 v[10:11], v[10:11], v[26:27]
    v_pk_add_f32 v[12:13], v[12:13], v[28:29]
    v_pk_add_f32 v[14:15], v[14:15], v[30:31]
    v_pk_add_f32 v[16:17], v[16:17], v[32:33]
    v_pk_add_f32 v[18:19], v[18:19], v[34:35]
    s_waitcnt lgkmcnt(0)
    v_pk_add_f32 v[36:37], v[36:37], v[52:53]
    v_pk_add_f32 v[38:39], v[38:39], v[54:55]
    v_pk_add_f32 v[40:41], v[40:41], v[56:57]
    v_pk_add_f32 v[42:43], v[42:43], v[58:59]
    v_pk_add_f32 v[44:45], v[44:45], v[60:61]
    v_pk_add_f32 v[46:47], v[46:47], v[62:63]
    v_pk_add_f32 v[48:49], v[48:49], v[64:65]
    v_pk_add_f32 v[50:51], v[50:51], v[66:67]
    v_pk_add_f32 v[4:5], v[4:5], v[36:37]
    v_pk_add_f32 v[6:7], v[6:7], v[38:39]
    v_pk_add_f32 v[8:9], v[8:9], v[40:41]
    v_pk_add_f32 v[10:11], v[10:11], v[42:43]
    v_pk_add_f32 v[12:13], v[12:13], v[44:45]
    v_pk_add_f32 v[14:15], v[14:15], v[46:47]
    v_pk_add_f32 v[16:17], v[16:17], v[48:49]
    v_pk_add_f32 v[18:19], v[18:19], v[50:51]
    v_pk_fma_f32 v[224:225], v[4:5], v[76:77], v[224:225] op_sel_hi:[1,0,1]
    v_pk_fma_f32 v[226:227], v[6:7], v[76:77], v[226:227] op_sel_hi:[1,0,1]
    v_pk_fma_f32 v[228:229], v[8:9], v[76:77], v[228:229] op_sel_hi:[1,0,1]
    v_pk_fma_f32 v[230:231], v[10:11], v[76:77], v[230:231] op_sel_hi:[1,0,1]
    v_pk_fma_f32 v[232:233], v[12:13], v[76:77], v[232:233] op_sel_hi:[1,0,1]
    v_pk_fma_f32 v[234:235], v[14:15], v[76:77], v[234:235] op_sel_hi:[1,0,1]
    v_pk_fma_f32 v[236:237], v[16:17], v[76:77], v[236:237] op_sel_hi:[1,0,1]
    v_pk_fma_f32 v[238:239], v[18:19], v[76:77], v[238:239] op_sel_hi:[1,0,1]
    v_cvt_pk_bf16_f32 v224, v224, v225
    v_cvt_pk_bf16_f32 v225, v226, v227
    v_cvt_pk_bf16_f32 v226, v228, v229
    v_cvt_pk_bf16_f32 v227, v230, v231
    v_cvt_pk_bf16_f32 v228, v232, v233
    v_cvt_pk_bf16_f32 v229, v234, v235
    v_cvt_pk_bf16_f32 v230, v236, v237
    v_cvt_pk_bf16_f32 v231, v238, v239
    v_permlane32_swap_b32 v224, v226
    v_permlane32_swap_b32 v225, v227
    v_permlane32_swap_b32 v228, v230
    v_permlane32_swap_b32 v229, v231
    s_nop 1
    buffer_store_dwordx4 v[224:227], v84, s[28:31], s52 offen
    buffer_store_dwordx4 v[228:231], v84, s[28:31], s52 offen offset:32
L_mk_end:
    s_endpgm
L_mk_compute:
    s_and_b32 s51, s3, 1
    s_lshr_b32 s53, s3, 1
    s_lshl_b32 s50, s43, 1
    s_add_u32 s50, s50, s51
    s_lshl_b32 s44, s44, 1
    s_add_u32 s44, s44, s53
    s_xor_b32 s54, s51, s53
    s_lshl_b32 s52, s51, 12
    v_and_b32 v136, 31, v1
    v_lshrrev_b32 v137, 5, v1
    v_bfe_u32 v138, v1, 1, 3
    v_xor_b32 v138, v138, v137
    s_lshl_b32 s45, s54, 1
    v_xor_b32 v138, s45, v138
    v_lshlrev_b32 v139, 7, v136
    v_add_u32 v139, s52, v139
    v_xor_b32 v140, 0, v138
    v_lshl_add_u32 v12, v140, 4, v139
    v_xor_b32 v140, 2, v138
    v_lshl_add_u32 v13, v140, 4, v139
    v_xor_b32 v140, 4, v138
    v_lshl_add_u32 v14, v140, 4, v139
    v_xor_b32 v140, 6, v138
    v_lshl_add_u32 v15, v140, 4, v139
    v_lshlrev_b32 v190, 10, v137
    v_bfe_u32 v136, v1, 2, 2
    v_lshl_add_u32 v190, v136, 7, v190
    v_lshrrev_b32 v136, 1, v136
    v_xor_b32 v136, s53, v136
    v_lshl_add_u32 v190, v136, 6, v190
    v_bfe_u32 v136, v1, 4, 1
    v_lshl_add_u32 v190, v136, 5, v190
    v_and_b32 v136, 3, v1
    v_lshl_add_u32 v190, v136, 3, v190
    s_lshl_b32 s45, s54, 11
    v_subrev_u32 v191, s45, v190
    v_add_u32 v190, s45, v190
    v_add_u32 v190, 65536, v190
    v_add_u32 v191, 65536, v191
    v_add_u32 v192, 0x10000, v190
    v_add_u32 v193, 0x10000, v191
    s_mul_i32 s52, s3, 384
    s_add_u32 s52, s52, 157696
    v_lshrrev_b32 v136, 2, v1
    v_xor_b32 v136, v136, v1
    v_and_b32 v136, 4, v136
    v_and_b32 v137, 3, v1
    v_or_b32 v136, v136, v137
    v_cmp_eq_u32 vcc, 0, v136
    v_mov_b32 v137, 0x3f803f80
    s_nop 0
    v_cndmask_b32 v16, 0, v137, vcc
    v_mov_b32 v60, 0
    v_mov_b32 v61, 0
    v_mov_b32 v17, v16
    v_mov_b32 v18, v16
    v_mov_b32 v19, v16
    s_lshl_b32 s55, s44, 1
    s_lshl_b32 s56, s55, 6
    s_add_u32 s56, s56, s50
    s_lshl_b32 s57, s56, 10
    s_lshl_b32 s58, s56, 11
    s_add_u32 s58, s58, 2097152
    s_add_u32 s59, s57, 65536
    s_add_u32 s60, s58, 131072
    s_mov_b32 s61, 0x3eb8aa3b
    v_and_b32 v4, 0x33, v1
    v_and_b32 v138, 4, v1
    v_lshl_add_u32 v4, v138, 1, v4
    v_bfe_u32 v138, v1, 3, 1
    v_lshl_add_u32 v4, v138, 2, v4
    v_lshlrev_b32 v4, 4, v4
    v_bfe_u32 v5, v1, 4, 1
    v_lshlrev_b32 v5, 17, v5
    v_lshrrev_b32 v139, 5, v1
    v_lshl_add_u32 v5, v139, 9, v5
    v_and_b32 v139, 7, v1
    v_lshl_add_u32 v5, v139, 5, v5
    v_bfe_u32 v139, v1, 3, 1
    v_lshl_add_u32 v5, v139, 4, v5
    v_and_b32 v6, 31, v1
    v_lshl_add_u32 v6, v6, 2, s52
    s_mul_i32 s45, s53, 768
    s_add_u32 s45, s45, 157696
    v_lshrrev_b32 v7, 5, v1
    v_lshl_add_u32 v7, v7, 4, s45
    s_mul_i32 s45, s51, 384
    s_add_u32 s45, s45, 157696
    v_and_b32 v9, 31, v1
    v_lshl_add_u32 v9, v9, 2, s45
    s_lshr_b32 s63, s44, 2
    s_and_b32 s64, s63, 1
    s_lshr_b32 s65, s63, 1
    s_add_u32 s65, s65, 1
    s_sub_u32 s66, 0, s65
    s_cmp_eq_u32 s64, 1
    s_cselect_b32 s65, s66, s65
    s_lshl_b32 s66, s50, 5
    s_add_u32 s66, s66, s65
    v_and_b32 v147, 31, v1
    v_add_u32 v147, s66, v147
    s_movk_i32 s48, 0x800
    v_cmp_gt_u32 s[46:47], s48, v147
    v_and_b32 v147, 2047, v147
    v_lshrrev_b32 v8, 5, v147
    v_lshlrev_b32 v8, 15, v8
    v_and_b32 v147, 31, v147
    v_lshl_add_u32 v8, v147, 4, v8
    v_and_b32 v147, 32, v1
    v_lshl_add_u32 v8, v147, 4, v8
    s_lshl_b32 s67, s44, 11
    s_add_u32 s67, s67, 6291456
    s_mov_b32 s62, 0x3b000000
    s_waitcnt lgkmcnt(0)
    s_mov_b32 s36, s26
    s_mov_b32 s37, s27
    s_mov_b32 s38, 0x2000000
    s_mov_b32 s39, 0x00020000
    v_mov_b32 v136, 0
    v_lshlrev_b32 v137, 2, v1
    s_cmp_eq_u32 s40, 2
    s_cbranch_scc0 L_mk_nw2
    v_add_u32 v138, 161728, v137
    ds_write_b32 v138, v136
    s_waitcnt lgkmcnt(0)
L_mk_nw2:
    s_cmp_eq_u32 s40, 1
    s_cbranch_scc0 L_mk_nw1
    s_cmp_eq_u32 s2, 0
    s_cbranch_scc0 L_mk_nw1
    v_lshlrev_b32 v137, 8, v1
    v_mov_b32 v140, 0
    v_mov_b32 v141, 0
    v_mov_b32 v142, 0
    v_mov_b32 v143, 0
    s_mov_b32 s48, 0xd80000
    buffer_store_dword v136, v137, s[36:39], s48 offen sc1
    s_mov_b32 s48, 0xd84000
    buffer_store_dword v136, v137, s[36:39], s48 offen sc1
    s_mov_b32 s48, 0xd88000
    buffer_store_dword v136, v137, s[36:39], s48 offen sc1
    s_mov_b32 s48, 0xd8c000
    buffer_store_dword v136, v137, s[36:39], s48 offen sc1
    s_mov_b32 s48, 0xd90000
    buffer_store_dword v136, v137, s[36:39], s48 offen sc1
    s_mov_b32 s48, 0xd94000
    buffer_store_dword v136, v137, s[36:39], s48 offen sc1
L_mk_nw1:
    v_mov_b32 v138, 1
    s_lshl_b32 s48, s44, 8
    s_add_u32 s48, s48, 0xd80000
    s_lshl_b32 s49, s50, 8
    s_add_u32 s49, s49, 0xd81000
    s_barrier
    ds_read_b128 v[20:23], v12 offset:0
    ds_read_b64_tr_b16 v[24:25], v190 offset:0
    ds_read_b64_tr_b16 v[26:27], v190 offset:512
    ds_read_b64_tr_b16 v[28:29], v190 offset:8192
    ds_read_b64_tr_b16 v[30:31], v190 offset:8704
    ds_read_b64_tr_b16 v[32:33], v190 offset:16384
    ds_read_b64_tr_b16 v[34:35], v190 offset:16896
    s_cmp_eq_u32 s40, 1
    s_cbranch_scc0 L_mk_nogo
    s_cmp_eq_u32 s2, 0
    s_cbranch_scc0 L_mk_nogo
    s_waitcnt vmcnt(0)
    s_mov_b64 exec, 1
    global_store_dword v136, v138, s[24:25] sc1
    s_mov_b64 exec, -1
L_mk_nogo:
    s_waitcnt lgkmcnt(0)
    v_mfma_f32_32x32x16_bf16 v[64:79], v[24:27], v[20:23], 0
    ds_read_b128 v[40:43], v13 offset:0
    ds_read_b64_tr_b16 v[44:45], v191 offset:2048
    ds_read_b64_tr_b16 v[46:47], v191 offset:2560
    ds_read_b64_tr_b16 v[48:49], v191 offset:10240
    ds_read_b64_tr_b16 v[50:51], v191 offset:10752
    ds_read_b64_tr_b16 v[52:53], v191 offset:18432
    ds_read_b64_tr_b16 v[54:55], v191 offset:18944
    v_mfma_f32_32x32x16_bf16 v[80:95], v[28:31], v[20:23], 0
    v_lshlrev_b32 v62, 16, v20
    v_and_b32 v63, 0xffff0000, v20
    v_fmac_f32 v60, v62, v62
    v_fmac_f32 v61, v63, v63
    v_lshlrev_b32 v62, 16, v21
    v_and_b32 v63, 0xffff0000, v21
    v_fmac_f32 v60, v62, v62
    v_fmac_f32 v61, v63, v63
    v_mfma_f32_32x32x16_bf16 v[96:111], v[20:23], v[32:35], 0
    v_lshlrev_b32 v62, 16, v22
    v_and_b32 v63, 0xffff0000, v22
    v_fmac_f32 v60, v62, v62
    v_fmac_f32 v61, v63, v63
    v_lshlrev_b32 v62, 16, v23
    v_and_b32 v63, 0xffff0000, v23
    v_fmac_f32 v60, v62, v62
    v_fmac_f32 v61, v63, v63
    s_waitcnt lgkmcnt(0)
    v_mfma_f32_32x32x16_bf16 v[64:79], v[44:47], v[40:43], v[64:79]
    ds_read_b128 v[20:23], v14 offset:0
    ds_read_b64_tr_b16 v[24:25], v190 offset:4096
    ds_read_b64_tr_b16 v[26:27], v190 offset:4608
    ds_read_b64_tr_b16 v[28:29], v190 offset:12288
    v_mfma_f32_16x16x32_bf16 v[128:131], v[16:19], v[40:43], 0
    ds_read_b64_tr_b16 v[30:31], v190 offset:12800
    ds_read_b64_tr_b16 v[32:33], v190 offset:20480
    v_mfma_f32_32x32x16_bf16 v[80:95], v[48:51], v[40:43], v[80:95]
    ds_read_b64_tr_b16 v[34:35], v190 offset:20992
    v_mfma_f32_32x32x16_bf16 v[96:111], v[40:43], v[52:55], v[96:111]
    s_waitcnt lgkmcnt(0)
    v_mfma_f32_32x32x16_bf16 v[64:79], v[24:27], v[20:23], v[64:79]
    ds_read_b128 v[40:43], v15 offset:0
    ds_read_b64_tr_b16 v[44:45], v191 offset:6144
    ds_read_b64_tr_b16 v[46:47], v191 offset:6656
    ds_read_b64_tr_b16 v[48:49], v191 offset:14336
    ds_read_b64_tr_b16 v[50:51], v191 offset:14848
    ds_read_b64_tr_b16 v[52:53], v191 offset:22528
    ds_read_b64_tr_b16 v[54:55], v191 offset:23040
    v_mfma_f32_32x32x16_bf16 v[80:95], v[28:31], v[20:23], v[80:95]
    v_lshlrev_b32 v62, 16, v20
    v_and_b32 v63, 0xffff0000, v20
    v_fmac_f32 v60, v62, v62
    v_fmac_f32 v61, v63, v63
    v_lshlrev_b32 v62, 16, v21
    v_and_b32 v63, 0xffff0000, v21
    v_fmac_f32 v60, v62, v62
    v_fmac_f32 v61, v63, v63
    v_mfma_f32_32x32x16_bf16 v[96:111], v[20:23], v[32:35], v[96:111]
    v_lshlrev_b32 v62, 16, v22
    v_and_b32 v63, 0xffff0000, v22
    v_fmac_f32 v60, v62, v62
    v_fmac_f32 v61, v63, v63
    v_lshlrev_b32 v62, 16, v23
    v_and_b32 v63, 0xffff0000, v23
    v_fmac_f32 v60, v62, v62
    v_fmac_f32 v61, v63, v63
    s_waitcnt lgkmcnt(0)
    s_barrier
    v_mfma_f32_32x32x16_bf16 v[64:79], v[44:47], v[40:43], v[64:79]
    ds_read_b128 v[20:23], v12 offset:8192
    ds_read_b64_tr_b16 v[24:25], v190 offset:24576
    ds_read_b64_tr_b16 v[26:27], v190 offset:25088
    ds_read_b64_tr_b16 v[28:29], v190 offset:32768
    v_mfma_f32_16x16x32_bf16 v[128:131], v[16:19], v[40:43], v[128:131]
    ds_read_b64_tr_b16 v[30:31], v190 offset:33280
    ds_read_b64_tr_b16 v[32:33], v190 offset:40960
    v_mfma_f32_32x32x16_bf16 v[80:95], v[48:51], v[40:43], v[80:95]
    ds_read_b64_tr_b16 v[34:35], v190 offset:41472
    v_mfma_f32_32x32x16_bf16 v[96:111], v[40:43], v[52:55], v[96:111]
    s_waitcnt lgkmcnt(0)
    v_mfma_f32_32x32x16_bf16 v[64:79], v[24:27], v[20:23], v[64:79]
    ds_read_b128 v[40:43], v13 offset:8192
    ds_read_b64_tr_b16 v[44:45], v191 offset:26624
    ds_read_b64_tr_b16 v[46:47], v191 offset:27136
    ds_read_b64_tr_b16 v[48:49], v191 offset:34816
    ds_read_b64_tr_b16 v[50:51], v191 offset:35328
    ds_read_b64_tr_b16 v[52:53], v191 offset:43008
    ds_read_b64_tr_b16 v[54:55], v191 offset:43520
    v_mfma_f32_32x32x16_bf16 v[80:95], v[28:31], v[20:23], v[80:95]
    v_lshlrev_b32 v62, 16, v20
    v_and_b32 v63, 0xffff0000, v20
    v_fmac_f32 v60, v62, v62
    v_fmac_f32 v61, v63, v63
    v_lshlrev_b32 v62, 16, v21
    v_and_b32 v63, 0xffff0000, v21
    v_fmac_f32 v60, v62, v62
    v_fmac_f32 v61, v63, v63
    v_mfma_f32_32x32x16_bf16 v[96:111], v[20:23], v[32:35], v[96:111]
    v_lshlrev_b32 v62, 16, v22
    v_and_b32 v63, 0xffff0000, v22
    v_fmac_f32 v60, v62, v62
    v_fmac_f32 v61, v63, v63
    v_lshlrev_b32 v62, 16, v23
    v_and_b32 v63, 0xffff0000, v23
    v_fmac_f32 v60, v62, v62
    v_fmac_f32 v61, v63, v63
    s_waitcnt lgkmcnt(0)
    v_mfma_f32_32x32x16_bf16 v[64:79], v[44:47], v[40:43], v[64:79]
    ds_read_b128 v[20:23], v14 offset:8192
    ds_read_b64_tr_b16 v[24:25], v190 offset:28672
    ds_read_b64_tr_b16 v[26:27], v190 offset:29184
    ds_read_b64_tr_b16 v[28:29], v190 offset:36864
    v_mfma_f32_16x16x32_bf16 v[128:131], v[16:19], v[40:43], v[128:131]
    ds_read_b64_tr_b16 v[30:31], v190 offset:37376
    ds_read_b64_tr_b16 v[32:33], v190 offset:45056
    v_mfma_f32_32x32x16_bf16 v[80:95], v[48:51], v[40:43], v[80:95]
    ds_read_b64_tr_b16 v[34:35], v190 offset:45568
    v_mfma_f32_32x32x16_bf16 v[96:111], v[40:43], v[52:55], v[96:111]
    s_waitcnt lgkmcnt(0)
    v_mfma_f32_32x32x16_bf16 v[64:79], v[24:27], v[20:23], v[64:79]
    ds_read_b128 v[40:43], v15 offset:8192
    ds_read_b64_tr_b16 v[44:45], v191 offset:30720
    ds_read_b64_tr_b16 v[46:47], v191 offset:31232
    ds_read_b64_tr_b16 v[48:49], v191 offset:38912
    ds_read_b64_tr_b16 v[50:51], v191 offset:39424
    ds_read_b64_tr_b16 v[52:53], v191 offset:47104
    ds_read_b64_tr_b16 v[54:55], v191 offset:47616
    v_mfma_f32_32x32x16_bf16 v[80:95], v[28:31], v[20:23], v[80:95]
    v_lshlrev_b32 v62, 16, v20
    v_and_b32 v63, 0xffff0000, v20
    v_fmac_f32 v60, v62, v62
    v_fmac_f32 v61, v63, v63
    v_lshlrev_b32 v62, 16, v21
    v_and_b32 v63, 0xffff0000, v21
    v_fmac_f32 v60, v62, v62
    v_fmac_f32 v61, v63, v63
    v_mfma_f32_32x32x16_bf16 v[96:111], v[20:23], v[32:35], v[96:111]
    v_lshlrev_b32 v62, 16, v22
    v_and_b32 v63, 0xffff0000, v22
    v_fmac_f32 v60, v62, v62
    v_fmac_f32 v61, v63, v63
    v_lshlrev_b32 v62, 16, v23
    v_and_b32 v63, 0xffff0000, v23
    v_fmac_f32 v60, v62, v62
    v_fmac_f32 v61, v63, v63
    s_waitcnt lgkmcnt(0)
    s_barrier
    v_mfma_f32_32x32x16_bf16 v[64:79], v[44:47], v[40:43], v[64:79]
    ds_read_b128 v[20:23], v12 offset:16384
    ds_read_b64_tr_b16 v[24:25], v190 offset:49152
    ds_read_b64_tr_b16 v[26:27], v190 offset:49664
    ds_read_b64_tr_b16 v[28:29], v190 offset:57344
    v_mfma_f32_16x16x32_bf16 v[128:131], v[16:19], v[40:43], v[128:131]
    ds_read_b64_tr_b16 v[30:31], v190 offset:57856
    ds_read_b64_tr_b16 v[32:33], v192 offset:0
    v_mfma_f32_32x32x16_bf16 v[80:95], v[48:51], v[40:43], v[80:95]
    ds_read_b64_tr_b16 v[34:35], v192 offset:512
    v_mfma_f32_32x32x16_bf16 v[96:111], v[40:43], v[52:55], v[96:111]
    s_waitcnt lgkmcnt(0)
    v_mfma_f32_32x32x16_bf16 v[64:79], v[24:27], v[20:23], v[64:79]
    ds_read_b128 v[40:43], v13 offset:16384
    ds_read_b64_tr_b16 v[44:45], v191 offset:51200
    ds_read_b64_tr_b16 v[46:47], v191 offset:51712
    ds_read_b64_tr_b16 v[48:49], v191 offset:59392
    ds_read_b64_tr_b16 v[50:51], v191 offset:59904
    ds_read_b64_tr_b16 v[52:53], v193 offset:2048
    ds_read_b64_tr_b16 v[54:55], v193 offset:2560
    v_mfma_f32_32x32x16_bf16 v[80:95], v[28:31], v[20:23], v[80:95]
    v_lshlrev_b32 v62, 16, v20
    v_and_b32 v63, 0xffff0000, v20
    v_fmac_f32 v60, v62, v62
    v_fmac_f32 v61, v63, v63
    v_lshlrev_b32 v62, 16, v21
    v_and_b32 v63, 0xffff0000, v21
    v_fmac_f32 v60, v62, v62
    v_fmac_f32 v61, v63, v63
    v_mfma_f32_32x32x16_bf16 v[96:111], v[20:23], v[32:35], v[96:111]
    v_lshlrev_b32 v62, 16, v22
    v_and_b32 v63, 0xffff0000, v22
    v_fmac_f32 v60, v62, v62
    v_fmac_f32 v61, v63, v63
    v_lshlrev_b32 v62, 16, v23
    v_and_b32 v63, 0xffff0000, v23
    v_fmac_f32 v60, v62, v62
    v_fmac_f32 v61, v63, v63
    s_waitcnt lgkmcnt(0)
    v_mfma_f32_32x32x16_bf16 v[64:79], v[44:47], v[40:43], v[64:79]
    ds_read_b128 v[20:23], v14 offset:16384
    ds_read_b64_tr_b16 v[24:25], v190 offset:53248
    ds_read_b64_tr_b16 v[26:27], v190 offset:53760
    ds_read_b64_tr_b16 v[28:29], v190 offset:61440
    v_mfma_f32_16x16x32_bf16 v[128:131], v[16:19], v[40:43], v[128:131]
    ds_read_b64_tr_b16 v[30:31], v190 offset:61952
    ds_read_b64_tr_b16 v[32:33], v192 offset:4096
    v_mfma_f32_32x32x16_bf16 v[80:95], v[48:51], v[40:43], v[80:95]
    ds_read_b64_tr_b16 v[34:35], v192 offset:4608
    v_mfma_f32_32x32x16_bf16 v[96:111], v[40:43], v[52:55], v[96:111]
    s_waitcnt lgkmcnt(0)
    v_mfma_f32_32x32x16_bf16 v[64:79], v[24:27], v[20:23], v[64:79]
    ds_read_b128 v[40:43], v15 offset:16384
    ds_read_b64_tr_b16 v[44:45], v191 offset:55296
    ds_read_b64_tr_b16 v[46:47], v191 offset:55808
    ds_read_b64_tr_b16 v[48:49], v191 offset:63488
    ds_read_b64_tr_b16 v[50:51], v191 offset:64000
    ds_read_b64_tr_b16 v[52:53], v193 offset:6144
    ds_read_b64_tr_b16 v[54:55], v193 offset:6656
    v_mfma_f32_32x32x16_bf16 v[80:95], v[28:31], v[20:23], v[80:95]
    v_lshlrev_b32 v62, 16, v20
    v_and_b32 v63, 0xffff0000, v20
    v_fmac_f32 v60, v62, v62
    v_fmac_f32 v61, v63, v63
    v_lshlrev_b32 v62, 16, v21
    v_and_b32 v63, 0xffff0000, v21
    v_fmac_f32 v60, v62, v62
    v_fmac_f32 v61, v63, v63
    v_mfma_f32_32x32x16_bf16 v[96:111], v[20:23], v[32:35], v[96:111]
    v_lshlrev_b32 v62, 16, v22
    v_and_b32 v63, 0xffff0000, v22
    v_fmac_f32 v60, v62, v62
    v_fmac_f32 v61, v63, v63
    v_lshlrev_b32 v62, 16, v23
    v_and_b32 v63, 0xffff0000, v23
    v_fmac_f32 v60, v62, v62
    v_fmac_f32 v61, v63, v63
    s_waitcnt lgkmcnt(0)
    s_barrier
    v_mfma_f32_32x32x16_bf16 v[64:79], v[44:47], v[40:43], v[64:79]
    ds_read_b128 v[20:23], v12 offset:24576
    ds_read_b64_tr_b16 v[24:25], v190 offset:0
    ds_read_b64_tr_b16 v[26:27], v190 offset:512
    ds_read_b64_tr_b16 v[28:29], v190 offset:8192
    v_mfma_f32_16x16x32_bf16 v[128:131], v[16:19], v[40:43], v[128:131]
    ds_read_b64_tr_b16 v[30:31], v190 offset:8704
    ds_read_b64_tr_b16 v[32:33], v190 offset:16384
    v_mfma_f32_32x32x16_bf16 v[80:95], v[48:51], v[40:43], v[80:95]
    ds_read_b64_tr_b16 v[34:35], v190 offset:16896
    v_mfma_f32_32x32x16_bf16 v[96:111], v[40:43], v[52:55], v[96:111]
    s_waitcnt lgkmcnt(0)
    v_mfma_f32_32x32x16_bf16 v[64:79], v[24:27], v[20:23], v[64:79]
    ds_read_b128 v[40:43], v13 offset:24576
    ds_read_b64_tr_b16 v[44:45], v191 offset:2048
    ds_read_b64_tr_b16 v[46:47], v191 offset:2560
    ds_read_b64_tr_b16 v[48:49], v191 offset:10240
    ds_read_b64_tr_b16 v[50:51], v191 offset:10752
    ds_read_b64_tr_b16 v[52:53], v191 offset:18432
    ds_read_b64_tr_b16 v[54:55], v191 offset:18944
    v_mfma_f32_32x32x16_bf16 v[80:95], v[28:31], v[20:23], v[80:95]
    v_lshlrev_b32 v62, 16, v20
    v_and_b32 v63, 0xffff0000, v20
    v_fmac_f32 v60, v62, v62
    v_fmac_f32 v61, v63, v63
    v_lshlrev_b32 v62, 16, v21
    v_and_b32 v63, 0xffff0000, v21
    v_fmac_f32 v60, v62, v62
    v_fmac_f32 v61, v63, v63
    v_mfma_f32_32x32x16_bf16 v[96:111], v[20:23], v[32:35], v[96:111]
    v_lshlrev_b32 v62, 16, v22
    v_and_b32 v63, 0xffff0000, v22
    v_fmac_f32 v60, v62, v62
    v_fmac_f32 v61, v63, v63
    v_lshlrev_b32 v62, 16, v23
    v_and_b32 v63, 0xffff0000, v23
    v_fmac_f32 v60, v62, v62
    v_fmac_f32 v61, v63, v63
    s_waitcnt lgkmcnt(0)
    v_mfma_f32_32x32x16_bf16 v[64:79], v[44:47], v[40:43], v[64:79]
    ds_read_b128 v[20:23], v14 offset:24576
    ds_read_b64_tr_b16 v[24:25], v190 offset:4096
    ds_read_b64_tr_b16 v[26:27], v190 offset:4608
    ds_read_b64_tr_b16 v[28:29], v190 offset:12288
    v_mfma_f32_16x16x32_bf16 v[128:131], v[16:19], v[40:43], v[128:131]
    ds_read_b64_tr_b16 v[30:31], v190 offset:12800
    ds_read_b64_tr_b16 v[32:33], v190 offset:20480
    v_mfma_f32_32x32x16_bf16 v[80:95], v[48:51], v[40:43], v[80:95]
    ds_read_b64_tr_b16 v[34:35], v190 offset:20992
    v_mfma_f32_32x32x16_bf16 v[96:111], v[40:43], v[52:55], v[96:111]
    s_waitcnt lgkmcnt(0)
    v_mfma_f32_32x32x16_bf16 v[64:79], v[24:27], v[20:23], v[64:79]
    ds_read_b128 v[40:43], v15 offset:24576
    ds_read_b64_tr_b16 v[44:45], v191 offset:6144
    ds_read_b64_tr_b16 v[46:47], v191 offset:6656
    ds_read_b64_tr_b16 v[48:49], v191 offset:14336
    ds_read_b64_tr_b16 v[50:51], v191 offset:14848
    ds_read_b64_tr_b16 v[52:53], v191 offset:22528
    ds_read_b64_tr_b16 v[54:55], v191 offset:23040
    v_mfma_f32_32x32x16_bf16 v[80:95], v[28:31], v[20:23], v[80:95]
    v_lshlrev_b32 v62, 16, v20
    v_and_b32 v63, 0xffff0000, v20
    v_fmac_f32 v60, v62, v62
    v_fmac_f32 v61, v63, v63
    v_lshlrev_b32 v62, 16, v21
    v_and_b32 v63, 0xffff0000, v21
    v_fmac_f32 v60, v62, v62
    v_fmac_f32 v61, v63, v63
    v_mfma_f32_32x32x16_bf16 v[96:111], v[20:23], v[32:35], v[96:111]
    v_lshlrev_b32 v62, 16, v22
    v_and_b32 v63, 0xffff0000, v22
    v_fmac_f32 v60, v62, v62
    v_fmac_f32 v61, v63, v63
    v_lshlrev_b32 v62, 16, v23
    v_and_b32 v63, 0xffff0000, v23
    v_fmac_f32 v60, v62, v62
    v_fmac_f32 v61, v63, v63
    s_waitcnt lgkmcnt(0)
    s_barrier
    v_mfma_f32_32x32x16_bf16 v[64:79], v[44:47], v[40:43], v[64:79]
    ds_read_b128 v[20:23], v12 offset:32768
    ds_read_b64_tr_b16 v[24:25], v190 offset:24576
    ds_read_b64_tr_b16 v[26:27], v190 offset:25088
    ds_read_b64_tr_b16 v[28:29], v190 offset:32768
    v_mfma_f32_16x16x32_bf16 v[128:131], v[16:19], v[40:43], v[128:131]
    ds_read_b64_tr_b16 v[30:31], v190 offset:33280
    ds_read_b64_tr_b16 v[32:33], v190 offset:40960
    v_mfma_f32_32x32x16_bf16 v[80:95], v[48:51], v[40:43], v[80:95]
    ds_read_b64_tr_b16 v[34:35], v190 offset:41472
    v_mfma_f32_32x32x16_bf16 v[96:111], v[40:43], v[52:55], v[96:111]
    s_waitcnt lgkmcnt(0)
    v_mfma_f32_32x32x16_bf16 v[64:79], v[24:27], v[20:23], v[64:79]
    ds_read_b128 v[40:43], v13 offset:32768
    ds_read_b64_tr_b16 v[44:45], v191 offset:26624
    ds_read_b64_tr_b16 v[46:47], v191 offset:27136
    ds_read_b64_tr_b16 v[48:49], v191 offset:34816
    ds_read_b64_tr_b16 v[50:51], v191 offset:35328
    ds_read_b64_tr_b16 v[52:53], v191 offset:43008
    ds_read_b64_tr_b16 v[54:55], v191 offset:43520
    v_mfma_f32_32x32x16_bf16 v[80:95], v[28:31], v[20:23], v[80:95]
    v_lshlrev_b32 v62, 16, v20
    v_and_b32 v63, 0xffff0000, v20
    v_fmac_f32 v60, v62, v62
    v_fmac_f32 v61, v63, v63
    v_lshlrev_b32 v62, 16, v21
    v_and_b32 v63, 0xffff0000, v21
    v_fmac_f32 v60, v62, v62
    v_fmac_f32 v61, v63, v63
    v_mfma_f32_32x32x16_bf16 v[96:111], v[20:23], v[32:35], v[96:111]
    v_lshlrev_b32 v62, 16, v22
    v_and_b32 v63, 0xffff0000, v22
    v_fmac_f32 v60, v62, v62
    v_fmac_f32 v61, v63, v63
    v_lshlrev_b32 v62, 16, v23
    v_and_b32 v63, 0xffff0000, v23
    v_fmac_f32 v60, v62, v62
    v_fmac_f32 v61, v63, v63
    s_waitcnt lgkmcnt(0)
    v_mfma_f32_32x32x16_bf16 v[64:79], v[44:47], v[40:43], v[64:79]
    ds_read_b128 v[20:23], v14 offset:32768
    ds_read_b64_tr_b16 v[24:25], v190 offset:28672
    ds_read_b64_tr_b16 v[26:27], v190 offset:29184
    ds_read_b64_tr_b16 v[28:29], v190 offset:36864
    v_mfma_f32_16x16x32_bf16 v[128:131], v[16:19], v[40:43], v[128:131]
    ds_read_b64_tr_b16 v[30:31], v190 offset:37376
    ds_read_b64_tr_b16 v[32:33], v190 offset:45056
    v_mfma_f32_32x32x16_bf16 v[80:95], v[48:51], v[40:43], v[80:95]
    ds_read_b64_tr_b16 v[34:35], v190 offset:45568
    v_mfma_f32_32x32x16_bf16 v[96:111], v[40:43], v[52:55], v[96:111]
    s_waitcnt lgkmcnt(0)
    v_mfma_f32_32x32x16_bf16 v[64:79], v[24:27], v[20:23], v[64:79]
    ds_read_b128 v[40:43], v15 offset:32768
    ds_read_b64_tr_b16 v[44:45], v191 offset:30720
    ds_read_b64_tr_b16 v[46:47], v191 offset:31232
    ds_read_b64_tr_b16 v[48:49], v191 offset:38912
    ds_read_b64_tr_b16 v[50:51], v191 offset:39424
    ds_read_b64_tr_b16 v[52:53], v191 offset:47104
    ds_read_b64_tr_b16 v[54:55], v191 offset:47616
    v_mfma_f32_32x32x16_bf16 v[80:95], v[28:31], v[20:23], v[80:95]
    v_lshlrev_b32 v62, 16, v20
    v_and_b32 v63, 0xffff0000, v20
    v_fmac_f32 v60, v62, v62
    v_fmac_f32 v61, v63, v63
    v_lshlrev_b32 v62, 16, v21
    v_and_b32 v63, 0xffff0000, v21
    v_fmac_f32 v60, v62, v62
    v_fmac_f32 v61, v63, v63
    v_mfma_f32_32x32x16_bf16 v[96:111], v[20:23], v[32:35], v[96:111]
    v_lshlrev_b32 v62, 16, v22
    v_and_b32 v63, 0xffff0000, v22
    v_fmac_f32 v60, v62, v62
    v_fmac_f32 v61, v63, v63
    v_lshlrev_b32 v62, 16, v23
    v_and_b32 v63, 0xffff0000, v23
    v_fmac_f32 v60, v62, v62
    v_fmac_f32 v61, v63, v63
    s_waitcnt lgkmcnt(0)
    s_barrier
    v_mfma_f32_32x32x16_bf16 v[64:79], v[44:47], v[40:43], v[64:79]
    ds_read_b128 v[20:23], v12 offset:40960
    ds_read_b64_tr_b16 v[24:25], v190 offset:49152
    ds_read_b64_tr_b16 v[26:27], v190 offset:49664
    ds_read_b64_tr_b16 v[28:29], v190 offset:57344
    v_mfma_f32_16x16x32_bf16 v[128:131], v[16:19], v[40:43], v[128:131]
    ds_read_b64_tr_b16 v[30:31], v190 offset:57856
    ds_read_b64_tr_b16 v[32:33], v192 offset:0
    v_mfma_f32_32x32x16_bf16 v[80:95], v[48:51], v[40:43], v[80:95]
    ds_read_b64_tr_b16 v[34:35], v192 offset:512
    v_mfma_f32_32x32x16_bf16 v[96:111], v[40:43], v[52:55], v[96:111]
    s_waitcnt lgkmcnt(0)
    v_mfma_f32_32x32x16_bf16 v[64:79], v[24:27], v[20:23], v[64:79]
    ds_read_b128 v[40:43], v13 offset:40960
    ds_read_b64_tr_b16 v[44:45], v191 offset:51200
    ds_read_b64_tr_b16 v[46:47], v191 offset:51712
    ds_read_b64_tr_b16 v[48:49], v191 offset:59392
    ds_read_b64_tr_b16 v[50:51], v191 offset:59904
    ds_read_b64_tr_b16 v[52:53], v193 offset:2048
    ds_read_b64_tr_b16 v[54:55], v193 offset:2560
    v_mfma_f32_32x32x16_bf16 v[80:95], v[28:31], v[20:23], v[80:95]
    v_lshlrev_b32 v62, 16, v20
    v_and_b32 v63, 0xffff0000, v20
    v_fmac_f32 v60, v62, v62
    v_fmac_f32 v61, v63, v63
    v_lshlrev_b32 v62, 16, v21
    v_and_b32 v63, 0xffff0000, v21
    v_fmac_f32 v60, v62, v62
    v_fmac_f32 v61, v63, v63
    v_mfma_f32_32x32x16_bf16 v[96:111], v[20:23], v[32:35], v[96:111]
    v_lshlrev_b32 v62, 16, v22
    v_and_b32 v63, 0xffff0000, v22
    v_fmac_f32 v60, v62, v62
    v_fmac_f32 v61, v63, v63
    v_lshlrev_b32 v62, 16, v23
    v_and_b32 v63, 0xffff0000, v23
    v_fmac_f32 v60, v62, v62
    v_fmac_f32 v61, v63, v63
    s_waitcnt lgkmcnt(0)
    v_mfma_f32_32x32x16_bf16 v[64:79], v[44:47], v[40:43], v[64:79]
    ds_read_b128 v[20:23], v14 offset:40960
    ds_read_b64_tr_b16 v[24:25], v190 offset:53248
    ds_read_b64_tr_b16 v[26:27], v190 offset:53760
    ds_read_b64_tr_b16 v[28:29], v190 offset:61440
    v_mfma_f32_16x16x32_bf16 v[128:131], v[16:19], v[40:43], v[128:131]
    ds_read_b64_tr_b16 v[30:31], v190 offset:61952
    ds_read_b64_tr_b16 v[32:33], v192 offset:4096
    v_mfma_f32_32x32x16_bf16 v[80:95], v[48:51], v[40:43], v[80:95]
    ds_read_b64_tr_b16 v[34:35], v192 offset:4608
    v_mfma_f32_32x32x16_bf16 v[96:111], v[40:43], v[52:55], v[96:111]
    s_waitcnt lgkmcnt(0)
    v_mfma_f32_32x32x16_bf16 v[64:79], v[24:27], v[20:23], v[64:79]
    ds_read_b128 v[40:43], v15 offset:40960
    ds_read_b64_tr_b16 v[44:45], v191 offset:55296
    ds_read_b64_tr_b16 v[46:47], v191 offset:55808
    ds_read_b64_tr_b16 v[48:49], v191 offset:63488
    ds_read_b64_tr_b16 v[50:51], v191 offset:64000
    ds_read_b64_tr_b16 v[52:53], v193 offset:6144
    ds_read_b64_tr_b16 v[54:55], v193 offset:6656
    v_mfma_f32_32x32x16_bf16 v[80:95], v[28:31], v[20:23], v[80:95]
    v_lshlrev_b32 v62, 16, v20
    v_and_b32 v63, 0xffff0000, v20
    v_fmac_f32 v60, v62, v62
    v_fmac_f32 v61, v63, v63
    v_lshlrev_b32 v62, 16, v21
    v_and_b32 v63, 0xffff0000, v21
    v_fmac_f32 v60, v62, v62
    v_fmac_f32 v61, v63, v63
    v_mfma_f32_32x32x16_bf16 v[96:111], v[20:23], v[32:35], v[96:111]
    v_lshlrev_b32 v62, 16, v22
    v_and_b32 v63, 0xffff0000, v22
    v_fmac_f32 v60, v62, v62
    v_fmac_f32 v61, v63, v63
    v_lshlrev_b32 v62, 16, v23
    v_and_b32 v63, 0xffff0000, v23
    v_fmac_f32 v60, v62, v62
    v_fmac_f32 v61, v63, v63
    s_waitcnt lgkmcnt(0)
    s_barrier
    v_mfma_f32_32x32x16_bf16 v[64:79], v[44:47], v[40:43], v[64:79]
    ds_read_b128 v[20:23], v12 offset:49152
    ds_read_b64_tr_b16 v[24:25], v190 offset:0
    ds_read_b64_tr_b16 v[26:27], v190 offset:512
    ds_read_b64_tr_b16 v[28:29], v190 offset:8192
    v_mfma_f32_16x16x32_bf16 v[128:131], v[16:19], v[40:43], v[128:131]
    ds_read_b64_tr_b16 v[30:31], v190 offset:8704
    ds_read_b64_tr_b16 v[32:33], v190 offset:16384
    v_mfma_f32_32x32x16_bf16 v[80:95], v[48:51], v[40:43], v[80:95]
    ds_read_b64_tr_b16 v[34:35], v190 offset:16896
    v_mfma_f32_32x32x16_bf16 v[96:111], v[40:43], v[52:55], v[96:111]
    s_waitcnt lgkmcnt(0)
    v_mfma_f32_32x32x16_bf16 v[64:79], v[24:27], v[20:23], v[64:79]
    ds_read_b128 v[40:43], v13 offset:49152
    ds_read_b64_tr_b16 v[44:45], v191 offset:2048
    ds_read_b64_tr_b16 v[46:47], v191 offset:2560
    ds_read_b64_tr_b16 v[48:49], v191 offset:10240
    ds_read_b64_tr_b16 v[50:51], v191 offset:10752
    ds_read_b64_tr_b16 v[52:53], v191 offset:18432
    ds_read_b64_tr_b16 v[54:55], v191 offset:18944
    v_mfma_f32_32x32x16_bf16 v[80:95], v[28:31], v[20:23], v[80:95]
    v_lshlrev_b32 v62, 16, v20
    v_and_b32 v63, 0xffff0000, v20
    v_fmac_f32 v60, v62, v62
    v_fmac_f32 v61, v63, v63
    v_lshlrev_b32 v62, 16, v21
    v_and_b32 v63, 0xffff0000, v21
    v_fmac_f32 v60, v62, v62
    v_fmac_f32 v61, v63, v63
    v_mfma_f32_32x32x16_bf16 v[96:111], v[20:23], v[32:35], v[96:111]
    v_lshlrev_b32 v62, 16, v22
    v_and_b32 v63, 0xffff0000, v22
    v_fmac_f32 v60, v62, v62
    v_fmac_f32 v61, v63, v63
    v_lshlrev_b32 v62, 16, v23
    v_and_b32 v63, 0xffff0000, v23
    v_fmac_f32 v60, v62, v62
    v_fmac_f32 v61, v63, v63
    s_waitcnt lgkmcnt(0)
    v_mfma_f32_32x32x16_bf16 v[64:79], v[44:47], v[40:43], v[64:79]
    ds_read_b128 v[20:23], v14 offset:49152
    ds_read_b64_tr_b16 v[24:25], v190 offset:4096
    ds_read_b64_tr_b16 v[26:27], v190 offset:4608
    ds_read_b64_tr_b16 v[28:29], v190 offset:12288
    v_mfma_f32_16x16x32_bf16 v[128:131], v[16:19], v[40:43], v[128:131]
    ds_read_b64_tr_b16 v[30:31], v190 offset:12800
    ds_read_b64_tr_b16 v[32:33], v190 offset:20480
    v_mfma_f32_32x32x16_bf16 v[80:95], v[48:51], v[40:43], v[80:95]
    ds_read_b64_tr_b16 v[34:35], v190 offset:20992
    v_mfma_f32_32x32x16_bf16 v[96:111], v[40:43], v[52:55], v[96:111]
    s_waitcnt lgkmcnt(0)
    v_mfma_f32_32x32x16_bf16 v[64:79], v[24:27], v[20:23], v[64:79]
    ds_read_b128 v[40:43], v15 offset:49152
    ds_read_b64_tr_b16 v[44:45], v191 offset:6144
    ds_read_b64_tr_b16 v[46:47], v191 offset:6656
    ds_read_b64_tr_b16 v[48:49], v191 offset:14336
    ds_read_b64_tr_b16 v[50:51], v191 offset:14848
    ds_read_b64_tr_b16 v[52:53], v191 offset:22528
    ds_read_b64_tr_b16 v[54:55], v191 offset:23040
    v_mfma_f32_32x32x16_bf16 v[80:95], v[28:31], v[20:23], v[80:95]
    v_lshlrev_b32 v62, 16, v20
    v_and_b32 v63, 0xffff0000, v20
    v_fmac_f32 v60, v62, v62
    v_fmac_f32 v61, v63, v63
    v_lshlrev_b32 v62, 16, v21
    v_and_b32 v63, 0xffff0000, v21
    v_fmac_f32 v60, v62, v62
    v_fmac_f32 v61, v63, v63
    v_mfma_f32_32x32x16_bf16 v[96:111], v[20:23], v[32:35], v[96:111]
    v_lshlrev_b32 v62, 16, v22
    v_and_b32 v63, 0xffff0000, v22
    v_fmac_f32 v60, v62, v62
    v_fmac_f32 v61, v63, v63
    v_lshlrev_b32 v62, 16, v23
    v_and_b32 v63, 0xffff0000, v23
    v_fmac_f32 v60, v62, v62
    v_fmac_f32 v61, v63, v63
    s_waitcnt lgkmcnt(0)
    s_barrier
    v_mfma_f32_32x32x16_bf16 v[64:79], v[44:47], v[40:43], v[64:79]
    ds_read_b128 v[20:23], v12 offset:57344
    ds_read_b64_tr_b16 v[24:25], v190 offset:24576
    ds_read_b64_tr_b16 v[26:27], v190 offset:25088
    ds_read_b64_tr_b16 v[28:29], v190 offset:32768
    v_mfma_f32_16x16x32_bf16 v[128:131], v[16:19], v[40:43], v[128:131]
    ds_read_b64_tr_b16 v[30:31], v190 offset:33280
    ds_read_b64_tr_b16 v[32:33], v190 offset:40960
    v_mfma_f32_32x32x16_bf16 v[80:95], v[48:51], v[40:43], v[80:95]
    ds_read_b64_tr_b16 v[34:35], v190 offset:41472
    v_mfma_f32_32x32x16_bf16 v[96:111], v[40:43], v[52:55], v[96:111]
    s_waitcnt lgkmcnt(0)
    v_mfma_f32_32x32x16_bf16 v[64:79], v[24:27], v[20:23], v[64:79]
    ds_read_b128 v[40:43], v13 offset:57344
    ds_read_b64_tr_b16 v[44:45], v191 offset:26624
    ds_read_b64_tr_b16 v[46:47], v191 offset:27136
    ds_read_b64_tr_b16 v[48:49], v191 offset:34816
    ds_read_b64_tr_b16 v[50:51], v191 offset:35328
    ds_read_b64_tr_b16 v[52:53], v191 offset:43008
    ds_read_b64_tr_b16 v[54:55], v191 offset:43520
    v_mfma_f32_32x32x16_bf16 v[80:95], v[28:31], v[20:23], v[80:95]
    v_lshlrev_b32 v62, 16, v20
    v_and_b32 v63, 0xffff0000, v20
    v_fmac_f32 v60, v62, v62
    v_fmac_f32 v61, v63, v63
    v_lshlrev_b32 v62, 16, v21
    v_and_b32 v63, 0xffff0000, v21
    v_fmac_f32 v60, v62, v62
    v_fmac_f32 v61, v63, v63
    v_mfma_f32_32x32x16_bf16 v[96:111], v[20:23], v[32:35], v[96:111]
    v_lshlrev_b32 v62, 16, v22
    v_and_b32 v63, 0xffff0000, v22
    v_fmac_f32 v60, v62, v62
    v_fmac_f32 v61, v63, v63
    v_lshlrev_b32 v62, 16, v23
    v_and_b32 v63, 0xffff0000, v23
    v_fmac_f32 v60, v62, v62
    v_fmac_f32 v61, v63, v63
    s_waitcnt lgkmcnt(0)
    v_mfma_f32_32x32x16_bf16 v[64:79], v[44:47], v[40:43], v[64:79]
    ds_read_b128 v[20:23], v14 offset:57344
    ds_read_b64_tr_b16 v[24:25], v190 offset:28672
    ds_read_b64_tr_b16 v[26:27], v190 offset:29184
    ds_read_b64_tr_b16 v[28:29], v190 offset:36864
    v_mfma_f32_16x16x32_bf16 v[128:131], v[16:19], v[40:43], v[128:131]
    ds_read_b64_tr_b16 v[30:31], v190 offset:37376
    ds_read_b64_tr_b16 v[32:33], v190 offset:45056
    v_mfma_f32_32x32x16_bf16 v[80:95], v[48:51], v[40:43], v[80:95]
    ds_read_b64_tr_b16 v[34:35], v190 offset:45568
    v_mfma_f32_32x32x16_bf16 v[96:111], v[40:43], v[52:55], v[96:111]
    s_waitcnt lgkmcnt(0)
    v_mfma_f32_32x32x16_bf16 v[64:79], v[24:27], v[20:23], v[64:79]
    ds_read_b128 v[40:43], v15 offset:57344
    ds_read_b64_tr_b16 v[44:45], v191 offset:30720
    ds_read_b64_tr_b16 v[46:47], v191 offset:31232
    ds_read_b64_tr_b16 v[48:49], v191 offset:38912
    ds_read_b64_tr_b16 v[50:51], v191 offset:39424
    ds_read_b64_tr_b16 v[52:53], v191 offset:47104
    ds_read_b64_tr_b16 v[54:55], v191 offset:47616
    v_mfma_f32_32x32x16_bf16 v[80:95], v[28:31], v[20:23], v[80:95]
    v_lshlrev_b32 v62, 16, v20
    v_and_b32 v63, 0xffff0000, v20
    v_fmac_f32 v60, v62, v62
    v_fmac_f32 v61, v63, v63
    v_lshlrev_b32 v62, 16, v21
    v_and_b32 v63, 0xffff0000, v21
    v_fmac_f32 v60, v62, v62
    v_fmac_f32 v61, v63, v63
    v_mfma_f32_32x32x16_bf16 v[96:111], v[20:23], v[32:35], v[96:111]
    v_lshlrev_b32 v62, 16, v22
    v_and_b32 v63, 0xffff0000, v22
    v_fmac_f32 v60, v62, v62
    v_fmac_f32 v61, v63, v63
    v_lshlrev_b32 v62, 16, v23
    v_and_b32 v63, 0xffff0000, v23
    v_fmac_f32 v60, v62, v62
    v_fmac_f32 v61, v63, v63
    s_waitcnt lgkmcnt(0)
    s_barrier
    v_mfma_f32_32x32x16_bf16 v[64:79], v[44:47], v[40:43], v[64:79]
    v_mfma_f32_16x16x32_bf16 v[128:131], v[16:19], v[40:43], v[128:131]
    v_mfma_f32_32x32x16_bf16 v[80:95], v[48:51], v[40:43], v[80:95]
    v_mfma_f32_32x32x16_bf16 v[96:111], v[40:43], v[52:55], v[96:111]
    v_add_f32 v60, v60, v61
    v_mov_b32 v140, s61
    v_mov_b32 v61, v60
    s_nop 7
    v_cvt_pk_bf16_f32 v28, v80, v81
    v_cvt_pk_bf16_f32 v29, v82, v83
    v_cvt_pk_bf16_f32 v30, v84, v85
    v_cvt_pk_bf16_f32 v31, v86, v87
    v_cvt_pk_bf16_f32 v32, v88, v89
    v_cvt_pk_bf16_f32 v33, v90, v91
    v_cvt_pk_bf16_f32 v34, v92, v93
    v_cvt_pk_bf16_f32 v35, v94, v95
    buffer_store_dwordx4 v[28:31], v4, s[36:39], s58 offen sc1
    buffer_store_dwordx4 v[32:35], v4, s[36:39], s60 offen sc1
    v_permlane32_swap_b32 v61, v60
    ds_write_b32 v6, v128 offset:128
    v_cvt_pk_bf16_f32 v36, v96, v97
    v_cvt_pk_bf16_f32 v37, v98, v99
    v_cvt_pk_bf16_f32 v38, v100, v101
    v_cvt_pk_bf16_f32 v39, v102, v103
    v_cvt_pk_bf16_f32 v40, v104, v105
    v_cvt_pk_bf16_f32 v41, v106, v107
    v_cvt_pk_bf16_f32 v42, v108, v109
    v_cvt_pk_bf16_f32 v43, v110, v111
    v_add_f32 v60, v60, v61
    v_mov_b32 v52, v36
    v_mov_b32 v53, v37
    v_mov_b32 v54, v38
    v_mov_b32 v55, v39
    ds_write_b32 v6, v60 offset:256
    v_mov_b32_dpp v36, v40 row_ror:8 row_mask:0xf bank_mask:0xc
    v_mov_b32_dpp v37, v41 row_ror:8 row_mask:0xf bank_mask:0xc
    v_mov_b32_dpp v38, v42 row_ror:8 row_mask:0xf bank_mask:0xc
    v_mov_b32_dpp v39, v43 row_ror:8 row_mask:0xf bank_mask:0xc
    v_mov_b32_dpp v40, v52 row_ror:8 row_mask:0xf bank_mask:0x3
    v_mov_b32_dpp v41, v53 row_ror:8 row_mask:0xf bank_mask:0x3
    v_mov_b32_dpp v42, v54 row_ror:8 row_mask:0xf bank_mask:0x3
    v_mov_b32_dpp v43, v55 row_ror:8 row_mask:0xf bank_mask:0x3
    buffer_store_dwordx4 v[36:39], v5, s[36:39], s58 offen offset:1024 sc1
    buffer_store_dwordx4 v[40:43], v5, s[36:39], s58 offen offset:1280 sc1
    v_pk_mul_f32 v[64:65], v[64:65], v[140:141] op_sel_hi:[1,0]
    v_pk_mul_f32 v[66:67], v[66:67], v[140:141] op_sel_hi:[1,0]
    v_pk_mul_f32 v[68:69], v[68:69], v[140:141] op_sel_hi:[1,0]
    v_pk_mul_f32 v[70:71], v[70:71], v[140:141] op_sel_hi:[1,0]
    v_pk_mul_f32 v[72:73], v[72:73], v[140:141] op_sel_hi:[1,0]
    v_pk_mul_f32 v[74:75], v[74:75], v[140:141] op_sel_hi:[1,0]
    v_pk_mul_f32 v[76:77], v[76:77], v[140:141] op_sel_hi:[1,0]
    v_pk_mul_f32 v[78:79], v[78:79], v[140:141] op_sel_hi:[1,0]
    v_cvt_pk_bf16_f32 v20, v64, v65
    v_cvt_pk_bf16_f32 v21, v66, v67
    v_cvt_pk_bf16_f32 v22, v68, v69
    v_cvt_pk_bf16_f32 v23, v70, v71
    v_cvt_pk_bf16_f32 v24, v72, v73
    v_cvt_pk_bf16_f32 v25, v74, v75
    v_cvt_pk_bf16_f32 v26, v76, v77
    v_cvt_pk_bf16_f32 v27, v78, v79
    buffer_store_dwordx4 v[20:23], v2, s[36:39], s57 offen sc1
    buffer_store_dwordx4 v[24:27], v2, s[36:39], s59 offen sc1
    s_mov_b32 s69, s49
    v_mov_b32 v136, 1
    v_mov_b32 v137, 0
    s_waitcnt lgkmcnt(0)
    s_barrier
    ds_read2_b32 v[128:129], v9 offset0:32 offset1:64
    ds_read2_b32 v[130:131], v9 offset0:224 offset1:0
    ds_read_b32 v131, v9 offset:1024
    ds_read_b128 v[64:67], v12 offset:0
    ds_read_b64_tr_b16 v[68:69], v190 offset:49152
    ds_read_b64_tr_b16 v[70:71], v190 offset:49664
    ds_read_b128 v[72:75], v13 offset:0
    ds_read_b64_tr_b16 v[76:77], v191 offset:51200
    ds_read_b64_tr_b16 v[78:79], v191 offset:51712
    ds_read_b128 v[80:83], v14 offset:0
    ds_read_b64_tr_b16 v[84:85], v190 offset:53248
    ds_read_b64_tr_b16 v[86:87], v190 offset:53760
    ds_read_b128 v[88:91], v15 offset:0
    ds_read_b64_tr_b16 v[92:93], v191 offset:55296
    ds_read_b64_tr_b16 v[94:95], v191 offset:55808
    s_waitcnt lgkmcnt(12)
    v_add_f32 v128, v128, v130
    v_add_f32 v60, v129, v131
    v_mul_f32 v142, s62, v128
    v_mul_f32 v147, v142, v142
    v_fma_f32 v147, v60, s62, -v147
    v_max_f32 v147, 0, v147
    v_add_f32 v147, 0x3727c5ac, v147
    v_rsq_f32 v143, v147
    v_sqrt_f32 v146, v147
    v_mul_f32 v145, 0xc0135761, v143
    v_mul_f32 v144, v143, v143
    v_mul_f32 v144, v144, v143
    v_mul_f32 v144, 0xbdd2d3e8, v144
    v_sub_f32 v142, 0, v142
    s_waitcnt lgkmcnt(0)
    v_mfma_f32_32x32x16_bf16 v[112:127], v[68:71], v[64:67], 0
    ds_read_b128 v[200:203], v12 offset:8192
    ds_read_b64_tr_b16 v[204:205], v190 offset:57344
    ds_read_b64_tr_b16 v[206:207], v190 offset:57856
    ds_read_b128 v[208:211], v13 offset:8192
    v_mfma_f32_32x32x16_bf16 v[112:127], v[76:79], v[72:75], v[112:127]
    ds_read_b64_tr_b16 v[212:213], v191 offset:59392
    ds_read_b64_tr_b16 v[214:215], v191 offset:59904
    ds_read_b128 v[216:219], v14 offset:8192
    ds_read_b64_tr_b16 v[220:221], v190 offset:61440
    v_mfma_f32_16x16x32_bf16 v[132:135], v[16:19], v[76:79], 0
    v_mfma_f32_32x32x16_bf16 v[112:127], v[84:87], v[80:83], v[112:127]
    ds_read_b64_tr_b16 v[222:223], v190 offset:61952
    ds_read_b128 v[224:227], v15 offset:8192
    ds_read_b64_tr_b16 v[228:229], v191 offset:63488
    ds_read_b64_tr_b16 v[230:231], v191 offset:64000
    v_mfma_f32_32x32x16_bf16 v[112:127], v[92:95], v[88:91], v[112:127]
    v_mfma_f32_16x16x32_bf16 v[132:135], v[16:19], v[92:95], v[132:135]
    s_waitcnt lgkmcnt(0)
    v_mfma_f32_32x32x16_bf16 v[112:127], v[204:207], v[200:203], v[112:127]
    ds_read_b128 v[64:67], v12 offset:16384
    ds_read_b64_tr_b16 v[68:69], v192 offset:0
    ds_read_b64_tr_b16 v[70:71], v192 offset:512
    ds_read_b128 v[72:75], v13 offset:16384
    v_mfma_f32_32x32x16_bf16 v[112:127], v[212:215], v[208:211], v[112:127]
    ds_read_b64_tr_b16 v[76:77], v193 offset:2048
    ds_read_b64_tr_b16 v[78:79], v193 offset:2560
    ds_read_b128 v[80:83], v14 offset:16384
    ds_read_b64_tr_b16 v[84:85], v192 offset:4096
    v_mfma_f32_16x16x32_bf16 v[132:135], v[16:19], v[212:215], v[132:135]
    v_mfma_f32_32x32x16_bf16 v[112:127], v[220:223], v[216:219], v[112:127]
    ds_read_b64_tr_b16 v[86:87], v192 offset:4608
    ds_read_b128 v[88:91], v15 offset:16384
    ds_read_b64_tr_b16 v[92:93], v193 offset:6144
    ds_read_b64_tr_b16 v[94:95], v193 offset:6656
    v_mfma_f32_32x32x16_bf16 v[112:127], v[228:231], v[224:227], v[112:127]
    v_mfma_f32_16x16x32_bf16 v[132:135], v[16:19], v[228:231], v[132:135]
    s_waitcnt lgkmcnt(0)
    v_mfma_f32_32x32x16_bf16 v[112:127], v[68:71], v[64:67], v[112:127]
    ds_read_b128 v[200:203], v12 offset:24576
    ds_read_b64_tr_b16 v[204:205], v190 offset:0
    ds_read_b64_tr_b16 v[206:207], v190 offset:512
    ds_read_b128 v[208:211], v13 offset:24576
    v_mfma_f32_32x32x16_bf16 v[112:127], v[76:79], v[72:75], v[112:127]
    ds_read_b64_tr_b16 v[212:213], v191 offset:2048
    ds_read_b64_tr_b16 v[214:215], v191 offset:2560
    ds_read_b128 v[216:219], v14 offset:24576
    ds_read_b64_tr_b16 v[220:221], v190 offset:4096
    v_mfma_f32_16x16x32_bf16 v[132:135], v[16:19], v[76:79], v[132:135]
    v_mfma_f32_32x32x16_bf16 v[112:127], v[84:87], v[80:83], v[112:127]
    ds_read_b64_tr_b16 v[222:223], v190 offset:4608
    ds_read_b128 v[224:227], v15 offset:24576
    ds_read_b64_tr_b16 v[228:229], v191 offset:6144
    ds_read_b64_tr_b16 v[230:231], v191 offset:6656
    v_mfma_f32_32x32x16_bf16 v[112:127], v[92:95], v[88:91], v[112:127]
    v_mfma_f32_16x16x32_bf16 v[132:135], v[16:19], v[92:95], v[132:135]
    s_waitcnt lgkmcnt(0)
    v_mfma_f32_32x32x16_bf16 v[112:127], v[204:207], v[200:203], v[112:127]
    ds_read_b128 v[64:67], v12 offset:32768
    ds_read_b64_tr_b16 v[68:69], v190 offset:8192
    ds_read_b64_tr_b16 v[70:71], v190 offset:8704
    ds_read_b128 v[72:75], v13 offset:32768
    v_mfma_f32_32x32x16_bf16 v[112:127], v[212:215], v[208:211], v[112:127]
    ds_read_b64_tr_b16 v[76:77], v191 offset:10240
    ds_read_b64_tr_b16 v[78:79], v191 offset:10752
    ds_read_b128 v[80:83], v14 offset:32768
    ds_read_b64_tr_b16 v[84:85], v190 offset:12288
    v_mfma_f32_16x16x32_bf16 v[132:135], v[16:19], v[212:215], v[132:135]
    v_mfma_f32_32x32x16_bf16 v[112:127], v[220:223], v[216:219], v[112:127]
    ds_read_b64_tr_b16 v[86:87], v190 offset:12800
    ds_read_b128 v[88:91], v15 offset:32768
    ds_read_b64_tr_b16 v[92:93], v191 offset:14336
    ds_read_b64_tr_b16 v[94:95], v191 offset:14848
    v_mfma_f32_32x32x16_bf16 v[112:127], v[228:231], v[224:227], v[112:127]
    v_mfma_f32_16x16x32_bf16 v[132:135], v[16:19], v[228:231], v[132:135]
    s_waitcnt lgkmcnt(0)
    v_mfma_f32_32x32x16_bf16 v[112:127], v[68:71], v[64:67], v[112:127]
    ds_read_b128 v[200:203], v12 offset:40960
    ds_read_b64_tr_b16 v[204:205], v190 offset:16384
    ds_read_b64_tr_b16 v[206:207], v190 offset:16896
    ds_read_b128 v[208:211], v13 offset:40960
    v_mfma_f32_32x32x16_bf16 v[112:127], v[76:79], v[72:75], v[112:127]
    ds_read_b64_tr_b16 v[212:213], v191 offset:18432
    ds_read_b64_tr_b16 v[214:215], v191 offset:18944
    ds_read_b128 v[216:219], v14 offset:40960
    ds_read_b64_tr_b16 v[220:221], v190 offset:20480
    v_mfma_f32_16x16x32_bf16 v[132:135], v[16:19], v[76:79], v[132:135]
    v_mfma_f32_32x32x16_bf16 v[112:127], v[84:87], v[80:83], v[112:127]
    ds_read_b64_tr_b16 v[222:223], v190 offset:20992
    ds_read_b128 v[224:227], v15 offset:40960
    ds_read_b64_tr_b16 v[228:229], v191 offset:22528
    ds_read_b64_tr_b16 v[230:231], v191 offset:23040
    v_mfma_f32_32x32x16_bf16 v[112:127], v[92:95], v[88:91], v[112:127]
    v_mfma_f32_16x16x32_bf16 v[132:135], v[16:19], v[92:95], v[132:135]
    s_waitcnt lgkmcnt(0)
    s_barrier
    v_mfma_f32_32x32x16_bf16 v[112:127], v[204:207], v[200:203], v[112:127]
    ds_read_b128 v[64:67], v12 offset:49152
    ds_read_b64_tr_b16 v[68:69], v190 offset:24576
    ds_read_b64_tr_b16 v[70:71], v190 offset:25088
    ds_read_b128 v[72:75], v13 offset:49152
    v_mfma_f32_32x32x16_bf16 v[112:127], v[212:215], v[208:211], v[112:127]
    ds_read_b64_tr_b16 v[76:77], v191 offset:26624
    ds_read_b64_tr_b16 v[78:79], v191 offset:27136
    ds_read_b128 v[80:83], v14 offset:49152
    ds_read_b64_tr_b16 v[84:85], v190 offset:28672
    v_mfma_f32_16x16x32_bf16 v[132:135], v[16:19], v[212:215], v[132:135]
    v_mfma_f32_32x32x16_bf16 v[112:127], v[220:223], v[216:219], v[112:127]
    ds_read_b64_tr_b16 v[86:87], v190 offset:29184
    ds_read_b128 v[88:91], v15 offset:49152
    ds_read_b64_tr_b16 v[92:93], v191 offset:30720
    ds_read_b64_tr_b16 v[94:95], v191 offset:31232
    v_mfma_f32_32x32x16_bf16 v[112:127], v[228:231], v[224:227], v[112:127]
    v_mfma_f32_16x16x32_bf16 v[132:135], v[16:19], v[228:231], v[132:135]
    s_waitcnt lgkmcnt(0)
    v_mfma_f32_32x32x16_bf16 v[112:127], v[68:71], v[64:67], v[112:127]
    ds_read_b128 v[200:203], v12 offset:57344
    ds_read_b64_tr_b16 v[204:205], v190 offset:32768
    ds_read_b64_tr_b16 v[206:207], v190 offset:33280
    ds_read_b128 v[208:211], v13 offset:57344
    v_mfma_f32_32x32x16_bf16 v[112:127], v[76:79], v[72:75], v[112:127]
    ds_read_b64_tr_b16 v[212:213], v191 offset:34816
    ds_read_b64_tr_b16 v[214:215], v191 offset:35328
    ds_read_b128 v[216:219], v14 offset:57344
    ds_read_b64_tr_b16 v[220:221], v190 offset:36864
    v_mfma_f32_16x16x32_bf16 v[132:135], v[16:19], v[76:79], v[132:135]
    v_mfma_f32_32x32x16_bf16 v[112:127], v[84:87], v[80:83], v[112:127]
    ds_read_b64_tr_b16 v[222:223], v190 offset:37376
    ds_read_b128 v[224:227], v15 offset:57344
    ds_read_b64_tr_b16 v[228:229], v191 offset:38912
    ds_read_b64_tr_b16 v[230:231], v191 offset:39424
    v_mfma_f32_32x32x16_bf16 v[112:127], v[92:95], v[88:91], v[112:127]
    v_mfma_f32_16x16x32_bf16 v[132:135], v[16:19], v[92:95], v[132:135]
    s_waitcnt lgkmcnt(0)
    v_mfma_f32_32x32x16_bf16 v[112:127], v[204:207], v[200:203], v[112:127]
    v_mfma_f32_32x32x16_bf16 v[112:127], v[212:215], v[208:211], v[112:127]
    v_mfma_f32_16x16x32_bf16 v[132:135], v[16:19], v[212:215], v[132:135]
    v_mfma_f32_32x32x16_bf16 v[112:127], v[220:223], v[216:219], v[112:127]
    v_mfma_f32_32x32x16_bf16 v[112:127], v[228:231], v[224:227], v[112:127]
    v_mfma_f32_16x16x32_bf16 v[132:135], v[16:19], v[228:231], v[132:135]
    s_nop 7
    ds_write_b32 v6, v132
    s_waitcnt lgkmcnt(0)
    v_mov_b32 v148, 161840
    v_mov_b32 v149, 1
    s_mov_b64 exec, 1
    ds_add_u32 v148, v149
    s_mov_b64 exec, -1
    s_waitcnt vmcnt(0)
    s_mov_b64 exec, 1
    buffer_atomic_add v136, v137, s[36:39], s48 offen sc1
    s_mov_b64 exec, -1
    s_mov_b32 s51, 0x400000
    v_mov_b32 v149, 161840
L_mk_cex:
    ds_read_b32 v148, v149
    s_waitcnt lgkmcnt(0)
    s_sub_u32 s51, s51, 1
    v_readfirstlane_b32 s49, v148
    s_cmp_eq_u32 s51, 0
    s_cbranch_scc1 L_mk_cexgo
    s_cmp_ge_u32 s49, 4
    s_cbranch_scc1 L_mk_cexgo
    s_sleep 1
    s_branch L_mk_cex
L_mk_cexgo:
    ds_read_b128 v[152:155], v7 offset:0
    ds_read_b128 v[156:159], v7 offset:32
    ds_read_b128 v[160:163], v7 offset:64
    ds_read_b128 v[164:167], v7 offset:96
    ds_read_b128 v[168:171], v7 offset:384
    ds_read_b128 v[172:175], v7 offset:416
    ds_read_b128 v[176:179], v7 offset:448
    ds_read_b128 v[180:183], v7 offset:480
    s_waitcnt lgkmcnt(0)
    v_mov_b32 v148, 161832
    v_mov_b32 v149, 1
    s_mov_b64 exec, 1
    ds_add_u32 v148, v149
    s_mov_b64 exec, -1
    v_pk_add_f32 v[152:153], v[152:153], v[168:169]
    v_pk_add_f32 v[154:155], v[154:155], v[170:171]
    v_pk_add_f32 v[156:157], v[156:157], v[172:173]
    v_pk_add_f32 v[158:159], v[158:159], v[174:175]
    v_pk_add_f32 v[160:161], v[160:161], v[176:177]
    v_pk_add_f32 v[162:163], v[162:163], v[178:179]
    v_pk_add_f32 v[164:165], v[164:165], v[180:181]
    v_pk_add_f32 v[166:167], v[166:167], v[182:183]
    v_pk_fma_f32 v[112:113], v[152:153], v[142:143], v[112:113] op_sel_hi:[1,0,1]
    v_pk_fma_f32 v[114:115], v[154:155], v[142:143], v[114:115] op_sel_hi:[1,0,1]
    v_pk_fma_f32 v[116:117], v[156:157], v[142:143], v[116:117] op_sel_hi:[1,0,1]
    v_pk_fma_f32 v[118:119], v[158:159], v[142:143], v[118:119] op_sel_hi:[1,0,1]
    v_pk_fma_f32 v[120:121], v[160:161], v[142:143], v[120:121] op_sel_hi:[1,0,1]
    v_pk_fma_f32 v[122:123], v[162:163], v[142:143], v[122:123] op_sel_hi:[1,0,1]
    v_pk_fma_f32 v[124:125], v[164:165], v[142:143], v[124:125] op_sel_hi:[1,0,1]
    v_pk_fma_f32 v[126:127], v[166:167], v[142:143], v[126:127] op_sel_hi:[1,0,1]
    v_pk_mul_f32 v[152:153], v[112:113], v[112:113]
    v_pk_mul_f32 v[154:155], v[114:115], v[114:115]
    v_pk_mul_f32 v[156:157], v[116:117], v[116:117]
    v_pk_mul_f32 v[158:159], v[118:119], v[118:119]
    v_pk_mul_f32 v[160:161], v[120:121], v[120:121]
    v_pk_mul_f32 v[162:163], v[122:123], v[122:123]
    v_pk_mul_f32 v[164:165], v[124:125], v[124:125]
    v_pk_mul_f32 v[166:167], v[126:127], v[126:127]
    v_pk_fma_f32 v[152:153], v[152:153], v[144:145], v[144:145] op_sel:[0,0,1] op_sel_hi:[1,0,1]
    v_pk_fma_f32 v[154:155], v[154:155], v[144:145], v[144:145] op_sel:[0,0,1] op_sel_hi:[1,0,1]
    v_pk_fma_f32 v[156:157], v[156:157], v[144:145], v[144:145] op_sel:[0,0,1] op_sel_hi:[1,0,1]
    v_pk_fma_f32 v[158:159], v[158:159], v[144:145], v[144:145] op_sel:[0,0,1] op_sel_hi:[1,0,1]
    v_pk_fma_f32 v[160:161], v[160:161], v[144:145], v[144:145] op_sel:[0,0,1] op_sel_hi:[1,0,1]
    v_pk_fma_f32 v[162:163], v[162:163], v[144:145], v[144:145] op_sel:[0,0,1] op_sel_hi:[1,0,1]
    v_pk_fma_f32 v[164:165], v[164:165], v[144:145], v[144:145] op_sel:[0,0,1] op_sel_hi:[1,0,1]
    v_pk_fma_f32 v[166:167], v[166:167], v[144:145], v[144:145] op_sel:[0,0,1] op_sel_hi:[1,0,1]
    v_pk_mul_f32 v[152:153], v[152:153], v[112:113]
    v_pk_mul_f32 v[154:155], v[154:155], v[114:115]
    v_pk_mul_f32 v[156:157], v[156:157], v[116:117]
    v_pk_mul_f32 v[158:159], v[158:159], v[118:119]
    v_pk_mul_f32 v[160:161], v[160:161], v[120:121]
    v_pk_mul_f32 v[162:163], v[162:163], v[122:123]
    v_pk_mul_f32 v[164:165], v[164:165], v[124:125]
    v_pk_mul_f32 v[166:167], v[166:167], v[126:127]
    v_exp_f32 v152, v152
    v_exp_f32 v153, v153
    v_exp_f32 v154, v154
    v_exp_f32 v155, v155
    v_exp_f32 v156, v156
    v_exp_f32 v157, v157
    v_exp_f32 v158, v158
    v_exp_f32 v159, v159
    v_exp_f32 v160, v160
    v_exp_f32 v161, v161
    v_exp_f32 v162, v162
    v_exp_f32 v163, v163
    v_exp_f32 v164, v164
    v_exp_f32 v165, v165
    v_exp_f32 v166, v166
    v_exp_f32 v167, v167
    v_pk_fma_f32 v[152:153], v[152:153], v[146:147], v[146:147] op_sel_hi:[1,0,0]
    v_pk_fma_f32 v[154:155], v[154:155], v[146:147], v[146:147] op_sel_hi:[1,0,0]
    v_pk_fma_f32 v[156:157], v[156:157], v[146:147], v[146:147] op_sel_hi:[1,0,0]
    v_pk_fma_f32 v[158:159], v[158:159], v[146:147], v[146:147] op_sel_hi:[1,0,0]
    v_pk_fma_f32 v[160:161], v[160:161], v[146:147], v[146:147] op_sel_hi:[1,0,0]
    v_pk_fma_f32 v[162:163], v[162:163], v[146:147], v[146:147] op_sel_hi:[1,0,0]
    v_pk_fma_f32 v[164:165], v[164:165], v[146:147], v[146:147] op_sel_hi:[1,0,0]
    v_pk_fma_f32 v[166:167], v[166:167], v[146:147], v[146:147] op_sel_hi:[1,0,0]
    v_rcp_f32 v152, v152
    v_rcp_f32 v153, v153
    v_rcp_f32 v154, v154
    v_rcp_f32 v155, v155
    v_rcp_f32 v156, v156
    v_rcp_f32 v157, v157
    v_rcp_f32 v158, v158
    v_rcp_f32 v159, v159
    v_rcp_f32 v160, v160
    v_rcp_f32 v161, v161
    v_rcp_f32 v162, v162
    v_rcp_f32 v163, v163
    v_rcp_f32 v164, v164
    v_rcp_f32 v165, v165
    v_rcp_f32 v166, v166
    v_rcp_f32 v167, v167
    v_pk_mul_f32 v[112:113], v[112:113], v[152:153]
    v_pk_mul_f32 v[114:115], v[114:115], v[154:155]
    v_pk_mul_f32 v[116:117], v[116:117], v[156:157]
    v_pk_mul_f32 v[118:119], v[118:119], v[158:159]
    v_pk_mul_f32 v[120:121], v[120:121], v[160:161]
    v_pk_mul_f32 v[122:123], v[122:123], v[162:163]
    v_pk_mul_f32 v[124:125], v[124:125], v[164:165]
    v_pk_mul_f32 v[126:127], v[126:127], v[166:167]
    v_cvt_pk_bf16_f32 v240, v112, v113
    v_cvt_pk_bf16_f32 v241, v114, v115
    v_cvt_pk_bf16_f32 v242, v116, v117
    v_cvt_pk_bf16_f32 v243, v118, v119
    v_cvt_pk_bf16_f32 v244, v120, v121
    v_cvt_pk_bf16_f32 v245, v122, v123
    v_cvt_pk_bf16_f32 v246, v124, v125
    v_cvt_pk_bf16_f32 v247, v126, v127
    v_cndmask_b32 v240, 0, v240, s[46:47]
    v_cndmask_b32 v241, 0, v241, s[46:47]
    v_cndmask_b32 v242, 0, v242, s[46:47]
    v_cndmask_b32 v243, 0, v243, s[46:47]
    v_cndmask_b32 v244, 0, v244, s[46:47]
    v_cndmask_b32 v245, 0, v245, s[46:47]
    v_cndmask_b32 v246, 0, v246, s[46:47]
    v_cndmask_b32 v247, 0, v247, s[46:47]
    buffer_store_dwordx4 v[240:243], v8, s[36:39], s67 offen sc1
    buffer_store_dwordx4 v[244:247], v8, s[36:39], s67 offen offset:1024 sc1
    s_bfe_u32 s41, s2, 0x10002
    s_lshl_b32 s41, s41, 2
    s_lshr_b32 s42, s2, 6
    s_add_u32 s41, s41, s42
    s_lshl_b32 s41, s41, 2
    s_and_b32 s42, s2, 3
    s_add_u32 s41, s41, s42
    s_lshl_b32 s59, s41, 17
    s_add_u32 s59, s59, 0x200000
    s_bfe_u32 s42, s2, 0x30003
    s_lshl_b32 s42, s42, 3
    s_lshl_b32 s43, s40, 1
    s_add_u32 s42, s42, s43
    s_lshl_b32 s43, s41, 6
    s_add_u32 s43, s43, s42
    s_lshl_b32 s43, s43, 10
    s_mul_i32 s44, s40, 2128
    s_lshl_b32 s45, s40, 11
    s_add_u32 s45, s45, s59
    s_lshr_b32 s46, s2, 3
    s_and_b32 s46, s46, 0
    s_lshl_b32 s46, s46, 14
    s_add_u32 s45, s45, s46
    s_mov_b32 m0, s44
    v_mov_b32 v132, 0xdddddddd
    v_and_b32 v140, 15, v1
    v_lshlrev_b32 v140, 5, v140
    v_lshrrev_b32 v141, 5, v1
    v_lshl_add_u32 v140, v141, 9, v140
    v_and_b32 v141, 16, v1
    v_cmp_eq_u32 vcc, 0, v141
    v_mov_b32 v142, 1040
    s_nop 0
    v_cndmask_b32 v134, v142, v140, vcc
    v_and_b32 v141, 27, v1
    v_cmp_eq_u32 vcc, 16, v141
    v_mov_b32 v142, 1072
    s_nop 0
    v_cndmask_b32 v134, v134, v142, vcc
    v_add_u32 v133, s44, v2
    s_lshl_b32 s52, s40, 2
    s_add_u32 s52, s52, 161728
    v_mov_b32 v135, s52
    v_mov_b32 v136, 0
    v_pk_mov_b32 v[12:13], 0, 0
    v_pk_mov_b32 v[14:15], 0, 0
    v_pk_mov_b32 v[16:17], 0, 0
    v_pk_mov_b32 v[18:19], 0, 0
    v_pk_mov_b32 v[20:21], 0, 0
    v_pk_mov_b32 v[22:23], 0, 0
    v_pk_mov_b32 v[24:25], 0, 0
    v_pk_mov_b32 v[26:27], 0, 0
    v_pk_mov_b32 v[28:29], 0, 0
    v_pk_mov_b32 v[30:31], 0, 0
    v_pk_mov_b32 v[32:33], 0, 0
    v_pk_mov_b32 v[34:35], 0, 0
    v_pk_mov_b32 v[36:37], 0, 0
    v_pk_mov_b32 v[38:39], 0, 0
    v_pk_mov_b32 v[40:41], 0, 0
    v_pk_mov_b32 v[42:43], 0, 0
    s_mov_b32 s51, 0x400000
    v_mov_b32 v141, 161832
L_mk_rel:
    ds_read_b32 v140, v141
    s_waitcnt lgkmcnt(0)
    s_sub_u32 s51, s51, 1
    v_readfirstlane_b32 s49, v140
    s_cmp_eq_u32 s51, 0
    s_cbranch_scc1 L_mk_relgo
    s_cmp_ge_u32 s49, 4
    s_cbranch_scc1 L_mk_relgo
    s_sleep 1
    s_branch L_mk_rel
L_mk_relgo:
    s_cmp_lg_u32 s40, 1
    s_cbranch_scc1 L_mk_noinit
    v_mov_b32 v144, 0x3f803f80
    v_mov_b32 v145, 0x3f803f80
    v_mov_b32 v146, 0x3f803f80
    v_mov_b32 v147, 0x3f803f80
    v_min_u32 v142, 39, v1
    v_mul_u32_u24 v142, 2128, v142
    ds_write_b128 v142, v[144:147] offset:2096
    ds_write_b128 v142, v[144:147] offset:2112
    ds_write_b128 v142, v[12:15] offset:2064
    ds_write_b128 v142, v[12:15] offset:2080
L_mk_noinit:
    s_setprio 3
    v_mov_b32 v141, 161812
    ds_read_b32 v140, v141
    s_waitcnt lgkmcnt(0)
    v_readfirstlane_b32 s57, v140
    s_nop 1
    s_cmp_lg_u32 s57, 0
    s_cbranch_scc1 L_mk_qwgo
    v_mov_b32 v140, 1
    v_mov_b32 v141, 0
    s_waitcnt vmcnt(0)
    s_mov_b64 exec, 1
    buffer_atomic_add v140, v141, s[36:39], s69 offen sc1
    s_mov_b64 exec, -1
    s_mov_b32 s51, 0x400000
    v_mov_b32 v141, 161812
L_mk_qw:
    ds_read_b32 v140, v141
    s_waitcnt lgkmcnt(0)
    s_sub_u32 s51, s51, 1
    v_readfirstlane_b32 s49, v140
    s_cmp_eq_u32 s51, 0
    s_cbranch_scc1 L_mk_qwgo
    s_cmp_ge_u32 s49, 1
    s_cbranch_scc1 L_mk_qwgo
    s_sleep 1
    s_branch L_mk_qw
L_mk_qwgo:
    buffer_load_dwordx4 v2, s[36:39], s45 offen sc1 lds
    buffer_load_dwordx4 v[4:7], v2, s[36:39], s43 offen sc1
    buffer_load_dwordx4 v[8:11], v2, s[36:39], s43 offen offset:1024 sc1
    buffer_load_dwordx4 v2, s[36:39], s45 offen offset:1024 sc1 lds
    s_add_u32 m0, s44, 8512
    s_add_u32 s45, s45, 8192
    buffer_load_dwordx4 v2, s[36:39], s45 offen sc1 lds
    buffer_load_dwordx4 v2, s[36:39], s45 offen offset:1024 sc1 lds
    s_mov_b32 s58, 0
    v_mov_b32 v140, 161848
    v_mov_b32 v141, 1
    s_mov_b64 exec, 1
    ds_add_u32 v140, v141
    s_mov_b64 exec, -1
    s_cmp_eq_u32 s57, 0
    s_cbranch_scc1 L_mk_hdone
    v_mov_b32 v140, 1
    v_mov_b32 v141, 0
    s_waitcnt vmcnt(6)
    s_mov_b64 exec, 1
    buffer_atomic_add v140, v141, s[36:39], s69 offen sc1
    s_mov_b64 exec, -1
L_mk_hdone:
    s_waitcnt vmcnt(3)
    ds_read_b128 v[108:111], v133 offset:0
    s_waitcnt lgkmcnt(0)
    v_mfma_f32_32x32x16_bf16 v[76:91], v[108:111], v[4:7], 0
    v_mfma_f32_32x32x16_bf16 v[92:107], v[108:111], v[8:11], 0
    v_mov_b32 v148, 1
    v_mov_b32 v133, v2
    s_waitcnt vmcnt(0)
    ds_write_b32 v135, v148
    s_nop 6
    v_max3_f32 v140, v76, v77, v78
    v_max3_f32 v140, v140, v79, v80
    v_max3_f32 v140, v140, v81, v82
    v_max3_f32 v140, v140, v83, v84
    v_max3_f32 v140, v140, v85, v86
    v_max3_f32 v140, v140, v87, v88
    v_max3_f32 v140, v140, v89, v90
    v_max_f32 v140, v140, v91
    v_max3_f32 v141, v92, v93, v94
    v_max3_f32 v141, v141, v95, v96
    v_max3_f32 v141, v141, v97, v98
    v_max3_f32 v141, v141, v99, v100
    v_max3_f32 v141, v141, v101, v102
    v_max3_f32 v141, v141, v103, v104
    v_max3_f32 v141, v141, v105, v106
    v_max_f32 v141, v141, v107
    v_mov_b32 v142, v140
    v_mov_b32 v143, v141
    s_nop 0
    v_permlane32_swap_b32 v142, v140
    v_permlane32_swap_b32 v143, v141
    s_nop 1
    v_max_f32 v140, v140, v142
    v_max_f32 v141, v141, v143
    v_pk_mul_f32 v[44:45], v[140:141], -1.0 op_sel_hi:[0,0]
    v_pk_mul_f32 v[46:47], v[140:141], -1.0 op_sel_hi:[0,0]
    v_pk_mul_f32 v[48:49], v[140:141], -1.0 op_sel_hi:[0,0]
    v_pk_mul_f32 v[50:51], v[140:141], -1.0 op_sel_hi:[0,0]
    v_pk_mul_f32 v[52:53], v[140:141], -1.0 op_sel_hi:[0,0]
    v_pk_mul_f32 v[54:55], v[140:141], -1.0 op_sel_hi:[0,0]
    v_pk_mul_f32 v[56:57], v[140:141], -1.0 op_sel_hi:[0,0]
    v_pk_mul_f32 v[58:59], v[140:141], -1.0 op_sel_hi:[0,0]
    v_pk_mul_f32 v[60:61], v[140:141], -1.0 op_sel:[1,0] op_sel_hi:[1,0]
    v_pk_mul_f32 v[62:63], v[140:141], -1.0 op_sel:[1,0] op_sel_hi:[1,0]
    v_pk_mul_f32 v[64:65], v[140:141], -1.0 op_sel:[1,0] op_sel_hi:[1,0]
    v_pk_mul_f32 v[66:67], v[140:141], -1.0 op_sel:[1,0] op_sel_hi:[1,0]
    v_pk_mul_f32 v[68:69], v[140:141], -1.0 op_sel:[1,0] op_sel_hi:[1,0]
    v_pk_mul_f32 v[70:71], v[140:141], -1.0 op_sel:[1,0] op_sel_hi:[1,0]
    v_pk_mul_f32 v[72:73], v[140:141], -1.0 op_sel:[1,0] op_sel_hi:[1,0]
    v_pk_mul_f32 v[74:75], v[140:141], -1.0 op_sel:[1,0] op_sel_hi:[1,0]
    v_pk_mov_b32 v[100:101], 0, 0
    v_pk_mov_b32 v[102:103], 0, 0
    v_pk_mov_b32 v[104:105], 0, 0
    v_pk_mov_b32 v[106:107], 0, 0
    s_mov_b32 s51, 0x400000
    v_mov_b32 v144, 161728
L_mk_p0:
    ds_read_b128 v[140:143], v144
    s_waitcnt lgkmcnt(0)
    v_min3_u32 v140, v140, v141, v142
    v_min_u32 v140, v140, v143
    s_sub_u32 s51, s51, 1
    v_readfirstlane_b32 s49, v140
    s_cmp_eq_u32 s51, 0
    s_cbranch_scc1 L_mk_p0go
    s_cmp_ge_u32 s49, 1
    s_cbranch_scc1 L_mk_p0go
    s_sleep 1
    s_branch L_mk_p0
L_mk_p0go:
    ds_read_b128 v[108:111], v133 offset:0
    ds_read_b128 v[112:115], v133 offset:2128
    ds_read_b128 v[116:119], v134 offset:1024
    ds_read_b128 v[120:123], v134 offset:1040
    ds_read_b128 v[124:127], v134 offset:1024
    ds_read_b128 v[128:131], v134 offset:1040
    s_waitcnt lgkmcnt(0)
    v_mfma_f32_32x32x16_bf16 v[76:91], v[108:111], v[4:7], v[44:59]
    s_mov_b32 s47, 8
    s_mov_b32 s48, 0x7665543
    s_mov_b32 s46, 0
    v_mov_b32 v137, v134
    v_mov_b32 v138, 161744
    s_nop 5
    s_setprio 0
.p2align 6
L_mk_loop:
    v_exp_f32 v76, v76
    v_exp_f32 v77, v77
    v_smfmac_f32_32x32x32_bf16 v[28:43], v[128:131], v[100:107], v132
    v_exp_f32 v78, v78
    v_exp_f32 v79, v79
    v_exp_f32 v80, v80
    v_mfma_f32_32x32x16_bf16 v[92:107], v[108:111], v[8:11], v[60:75]
    ds_read_b128 v[124:127], v134 offset:3152
    ds_read_b128 v[128:131], v134 offset:3168
    v_exp_f32 v81, v81
    v_exp_f32 v82, v82
    v_exp_f32 v83, v83
    v_exp_f32 v84, v84
    v_exp_f32 v85, v85
    v_exp_f32 v86, v86
    v_smfmac_f32_32x32x32_bf16 v[12:27], v[116:119], v[76:83], v132
    v_exp_f32 v87, v87
    v_exp_f32 v88, v88
    v_exp_f32 v89, v89
    v_exp_f32 v90, v90
    v_exp_f32 v91, v91
    v_exp_f32 v92, v92
    v_exp_f32 v93, v93
    v_smfmac_f32_32x32x32_bf16 v[12:27], v[120:123], v[84:91], v132
    v_exp_f32 v94, v94
    v_exp_f32 v95, v95
    v_exp_f32 v96, v96
    s_waitcnt lgkmcnt(0)
    v_mfma_f32_32x32x16_bf16 v[76:91], v[112:115], v[4:7], v[44:59]
    ds_read_b128 v[108:111], v133 offset:4256
    v_exp_f32 v97, v97
    v_exp_f32 v98, v98
    v_exp_f32 v99, v99
    v_exp_f32 v100, v100
    v_exp_f32 v101, v101
    v_exp_f32 v102, v102
    v_smfmac_f32_32x32x32_bf16 v[28:43], v[116:119], v[92:99], v132
    v_exp_f32 v103, v103
    v_exp_f32 v104, v104
    v_exp_f32 v105, v105
    v_exp_f32 v106, v106
    v_exp_f32 v107, v107
    v_exp_f32 v76, v76
    v_exp_f32 v77, v77
    v_smfmac_f32_32x32x32_bf16 v[28:43], v[120:123], v[100:107], v132
    v_exp_f32 v78, v78
    v_exp_f32 v79, v79
    v_exp_f32 v80, v80
    v_mfma_f32_32x32x16_bf16 v[92:107], v[112:115], v[8:11], v[60:75]
    ds_read_b128 v[116:119], v134 offset:5280
    ds_read_b128 v[120:123], v134 offset:5296
    v_exp_f32 v81, v81
    v_exp_f32 v82, v82
    v_exp_f32 v83, v83
    v_exp_f32 v84, v84
    v_exp_f32 v85, v85
    v_exp_f32 v86, v86
    v_smfmac_f32_32x32x32_bf16 v[12:27], v[124:127], v[76:83], v132
    v_exp_f32 v87, v87
    v_exp_f32 v88, v88
    v_exp_f32 v89, v89
    v_exp_f32 v90, v90
    v_exp_f32 v91, v91
    v_exp_f32 v92, v92
    v_exp_f32 v93, v93
    v_smfmac_f32_32x32x32_bf16 v[12:27], v[128:131], v[84:91], v132
    v_exp_f32 v94, v94
    v_exp_f32 v95, v95
    v_exp_f32 v96, v96
    s_waitcnt lgkmcnt(0)
    v_mfma_f32_32x32x16_bf16 v[76:91], v[108:111], v[4:7], v[44:59]
    ds_read_b128 v[112:115], v133 offset:6384
    v_exp_f32 v97, v97
    v_exp_f32 v98, v98
    v_exp_f32 v99, v99
    v_exp_f32 v100, v100
    v_exp_f32 v101, v101
    v_exp_f32 v102, v102
    v_smfmac_f32_32x32x32_bf16 v[28:43], v[124:127], v[92:99], v132
    v_exp_f32 v103, v103
    v_exp_f32 v104, v104
    v_exp_f32 v105, v105
    v_exp_f32 v106, v106
    v_exp_f32 v107, v107
    v_exp_f32 v76, v76
    v_exp_f32 v77, v77
    v_smfmac_f32_32x32x32_bf16 v[28:43], v[128:131], v[100:107], v132
    v_exp_f32 v78, v78
    v_exp_f32 v79, v79
    v_exp_f32 v80, v80
    v_mfma_f32_32x32x16_bf16 v[92:107], v[108:111], v[8:11], v[60:75]
    ds_read_b128 v[124:127], v134 offset:7408
    ds_read_b128 v[128:131], v134 offset:7424
    v_exp_f32 v81, v81
    v_exp_f32 v82, v82
    v_exp_f32 v83, v83
    v_exp_f32 v84, v84
    v_exp_f32 v85, v85
    v_exp_f32 v86, v86
    v_smfmac_f32_32x32x32_bf16 v[12:27], v[116:119], v[76:83], v132
    v_exp_f32 v87, v87
    v_exp_f32 v88, v88
    v_exp_f32 v89, v89
    v_exp_f32 v90, v90
    v_exp_f32 v91, v91
    v_exp_f32 v92, v92
    v_exp_f32 v93, v93
    v_smfmac_f32_32x32x32_bf16 v[12:27], v[120:123], v[84:91], v132
    v_exp_f32 v94, v94
    v_exp_f32 v95, v95
    v_exp_f32 v96, v96
    s_waitcnt lgkmcnt(0)
    v_mfma_f32_32x32x16_bf16 v[76:91], v[112:115], v[4:7], v[44:59]
    ds_read_b128 v[108:111], v133 offset:8512
    v_exp_f32 v97, v97
    v_exp_f32 v98, v98
    v_exp_f32 v99, v99
    v_exp_f32 v100, v100
    v_exp_f32 v101, v101
    v_exp_f32 v102, v102
    v_smfmac_f32_32x32x32_bf16 v[28:43], v[116:119], v[92:99], v132
    v_exp_f32 v103, v103
    v_exp_f32 v104, v104
    v_exp_f32 v105, v105
    v_exp_f32 v106, v106
    v_exp_f32 v107, v107
    v_exp_f32 v76, v76
    v_exp_f32 v77, v77
    v_smfmac_f32_32x32x32_bf16 v[28:43], v[120:123], v[100:107], v132
    v_exp_f32 v78, v78
    v_exp_f32 v79, v79
    v_exp_f32 v80, v80
    v_mfma_f32_32x32x16_bf16 v[92:107], v[112:115], v[8:11], v[60:75]
    ds_read_b128 v[116:119], v134 offset:9536
    ds_read_b128 v[120:123], v134 offset:9552
    v_exp_f32 v81, v81
    v_exp_f32 v82, v82
    v_exp_f32 v83, v83
    v_exp_f32 v84, v84
    v_exp_f32 v85, v85
    v_exp_f32 v86, v86
    v_smfmac_f32_32x32x32_bf16 v[12:27], v[124:127], v[76:83], v132
    v_exp_f32 v87, v87
    v_exp_f32 v88, v88
    v_exp_f32 v89, v89
    v_exp_f32 v90, v90
    v_exp_f32 v91, v91
    v_exp_f32 v92, v92
    v_exp_f32 v93, v93
    v_smfmac_f32_32x32x32_bf16 v[12:27], v[128:131], v[84:91], v132
    v_exp_f32 v94, v94
    v_exp_f32 v95, v95
    v_exp_f32 v96, v96
    s_waitcnt lgkmcnt(0)
    v_mfma_f32_32x32x16_bf16 v[76:91], v[108:111], v[4:7], v[44:59]
    ds_read_b128 v[112:115], v133 offset:10640
    v_exp_f32 v97, v97
    v_exp_f32 v98, v98
    v_exp_f32 v99, v99
    v_exp_f32 v100, v100
    v_exp_f32 v101, v101
    v_exp_f32 v102, v102
    v_smfmac_f32_32x32x32_bf16 v[28:43], v[124:127], v[92:99], v132
    v_exp_f32 v103, v103
    v_exp_f32 v104, v104
    v_exp_f32 v105, v105
    v_exp_f32 v106, v106
    v_exp_f32 v107, v107
    v_exp_f32 v76, v76
    v_exp_f32 v77, v77
    v_smfmac_f32_32x32x32_bf16 v[28:43], v[128:131], v[100:107], v132
    v_exp_f32 v78, v78
    v_exp_f32 v79, v79
    v_exp_f32 v80, v80
    v_mfma_f32_32x32x16_bf16 v[92:107], v[108:111], v[8:11], v[60:75]
    ds_read_b128 v[124:127], v134 offset:11664
    ds_read_b128 v[128:131], v134 offset:11680
    v_exp_f32 v81, v81
    v_exp_f32 v82, v82
    v_exp_f32 v83, v83
    v_exp_f32 v84, v84
    v_exp_f32 v85, v85
    v_exp_f32 v86, v86
    v_smfmac_f32_32x32x32_bf16 v[12:27], v[116:119], v[76:83], v132
    v_exp_f32 v87, v87
    v_exp_f32 v88, v88
    v_exp_f32 v89, v89
    v_exp_f32 v90, v90
    v_exp_f32 v91, v91
    v_exp_f32 v92, v92
    v_exp_f32 v93, v93
    v_smfmac_f32_32x32x32_bf16 v[12:27], v[120:123], v[84:91], v132
    v_exp_f32 v94, v94
    v_exp_f32 v95, v95
    v_exp_f32 v96, v96
    s_waitcnt lgkmcnt(0)
    v_mfma_f32_32x32x16_bf16 v[76:91], v[112:115], v[4:7], v[44:59]
    ds_read_b128 v[108:111], v133 offset:12768
    v_exp_f32 v97, v97
    v_exp_f32 v98, v98
    v_exp_f32 v99, v99
    v_exp_f32 v100, v100
    v_exp_f32 v101, v101
    v_exp_f32 v102, v102
    v_smfmac_f32_32x32x32_bf16 v[28:43], v[116:119], v[92:99], v132
    v_exp_f32 v103, v103
    v_exp_f32 v104, v104
    v_exp_f32 v105, v105
    v_exp_f32 v106, v106
    v_exp_f32 v107, v107
    v_exp_f32 v76, v76
    v_exp_f32 v77, v77
    v_smfmac_f32_32x32x32_bf16 v[28:43], v[120:123], v[100:107], v132
    v_exp_f32 v78, v78
    v_exp_f32 v79, v79
    v_exp_f32 v80, v80
    v_mfma_f32_32x32x16_bf16 v[92:107], v[112:115], v[8:11], v[60:75]
    ds_read_b128 v[116:119], v134 offset:13792
    ds_read_b128 v[120:123], v134 offset:13808
    v_exp_f32 v81, v81
    v_exp_f32 v82, v82
    v_exp_f32 v83, v83
    v_exp_f32 v84, v84
    v_exp_f32 v85, v85
    v_exp_f32 v86, v86
    v_smfmac_f32_32x32x32_bf16 v[12:27], v[124:127], v[76:83], v132
    v_exp_f32 v87, v87
    v_exp_f32 v88, v88
    v_exp_f32 v89, v89
    v_exp_f32 v90, v90
    v_exp_f32 v91, v91
    v_exp_f32 v92, v92
    v_exp_f32 v93, v93
    v_smfmac_f32_32x32x32_bf16 v[12:27], v[128:131], v[84:91], v132
    v_exp_f32 v94, v94
    v_exp_f32 v95, v95
    v_exp_f32 v96, v96
    s_waitcnt lgkmcnt(0)
    v_mfma_f32_32x32x16_bf16 v[76:91], v[108:111], v[4:7], v[44:59]
    ds_read_b128 v[112:115], v133 offset:14896
    v_exp_f32 v97, v97
    v_exp_f32 v98, v98
    v_exp_f32 v99, v99
    v_exp_f32 v100, v100
    v_exp_f32 v101, v101
    v_exp_f32 v102, v102
    v_smfmac_f32_32x32x32_bf16 v[28:43], v[124:127], v[92:99], v132
    v_exp_f32 v103, v103
    v_exp_f32 v104, v104
    v_exp_f32 v105, v105
    v_exp_f32 v106, v106
    v_exp_f32 v107, v107
    v_exp_f32 v76, v76
    v_exp_f32 v77, v77
    v_smfmac_f32_32x32x32_bf16 v[28:43], v[128:131], v[100:107], v132
    v_exp_f32 v78, v78
    v_exp_f32 v79, v79
    v_exp_f32 v80, v80
    v_mfma_f32_32x32x16_bf16 v[92:107], v[108:111], v[8:11], v[60:75]
    ds_read_b128 v[124:127], v134 offset:15920
    ds_read_b128 v[128:131], v134 offset:15936
    ds_read_b128 v[140:143], v138
    v_exp_f32 v81, v81
    v_exp_f32 v82, v82
    v_exp_f32 v83, v83
    v_exp_f32 v84, v84
    v_exp_f32 v85, v85
    v_exp_f32 v86, v86
    v_smfmac_f32_32x32x32_bf16 v[12:27], v[116:119], v[76:83], v132
    s_add_u32 s46, s46, 17024
    s_cmp_eq_u32 s46, 85120
    s_cselect_b32 s46, 0, s46
    v_exp_f32 v87, v87
    v_exp_f32 v88, v88
    v_exp_f32 v89, v89
    v_exp_f32 v90, v90
    v_exp_f32 v91, v91
    v_exp_f32 v92, v92
    v_exp_f32 v93, v93
    v_smfmac_f32_32x32x32_bf16 v[12:27], v[120:123], v[84:91], v132
    v_exp_f32 v94, v94
    v_add_u32 v133, s46, v2
    v_exp_f32 v95, v95
    v_exp_f32 v96, v96
    s_waitcnt lgkmcnt(0)
    v_min3_u32 v140, v140, v141, v142
    s_and_b32 s50, s48, 15
    v_min_u32 v140, v140, v143
    s_lshr_b32 s48, s48, 4
    v_cmp_gt_u32 vcc, s50, v140
    v_mfma_f32_32x32x16_bf16 v[76:91], v[112:115], v[4:7], v[44:59]
    v_exp_f32 v97, v97
    v_exp_f32 v98, v98
    v_exp_f32 v99, v99
    v_exp_f32 v100, v100
    s_cbranch_vccnz L_mk_ps0
L_mk_pb0:
    ds_read_b128 v[108:111], v133 offset:0
    v_exp_f32 v101, v101
    v_exp_f32 v102, v102
    v_smfmac_f32_32x32x32_bf16 v[28:43], v[116:119], v[92:99], v132
    v_exp_f32 v103, v103
    v_exp_f32 v104, v104
    v_exp_f32 v105, v105
    v_exp_f32 v106, v106
    v_exp_f32 v107, v107
    v_exp_f32 v76, v76
    v_exp_f32 v77, v77
    v_smfmac_f32_32x32x32_bf16 v[28:43], v[120:123], v[100:107], v132
    v_exp_f32 v78, v78
    v_add_u32 v134, s46, v137
    v_exp_f32 v79, v79
    v_exp_f32 v80, v80
    v_mfma_f32_32x32x16_bf16 v[92:107], v[112:115], v[8:11], v[60:75]
    ds_read_b128 v[116:119], v134 offset:1024
    ds_read_b128 v[120:123], v134 offset:1040
    v_exp_f32 v81, v81
    v_exp_f32 v82, v82
    v_exp_f32 v83, v83
    v_exp_f32 v84, v84
    v_exp_f32 v85, v85
    v_exp_f32 v86, v86
    v_smfmac_f32_32x32x32_bf16 v[12:27], v[124:127], v[76:83], v132
    v_exp_f32 v87, v87
    v_exp_f32 v88, v88
    v_exp_f32 v89, v89
    v_exp_f32 v90, v90
    v_exp_f32 v91, v91
    v_exp_f32 v92, v92
    v_exp_f32 v93, v93
    v_smfmac_f32_32x32x32_bf16 v[12:27], v[128:131], v[84:91], v132
    v_exp_f32 v94, v94
    v_exp_f32 v95, v95
    v_exp_f32 v96, v96
    s_waitcnt lgkmcnt(0)
    v_mfma_f32_32x32x16_bf16 v[76:91], v[108:111], v[4:7], v[44:59]
    ds_read_b128 v[112:115], v133 offset:2128
    v_exp_f32 v97, v97
    v_exp_f32 v98, v98
    v_exp_f32 v99, v99
    v_exp_f32 v100, v100
    v_exp_f32 v101, v101
    v_exp_f32 v102, v102
    v_add_u32 v136, 8, v136
    v_smfmac_f32_32x32x32_bf16 v[28:43], v[124:127], v[92:99], v132
    ds_write_b32 v135, v136 offset:32
    s_sub_u32 s47, s47, 1
    s_cmp_lg_u32 s47, 0
    v_exp_f32 v103, v103
    v_exp_f32 v104, v104
    v_exp_f32 v105, v105
    v_exp_f32 v106, v106
    v_exp_f32 v107, v107
    s_cbranch_scc1 L_mk_loop
    s_nop 0
    v_smfmac_f32_32x32x32_bf16 v[28:43], v[128:131], v[100:107], v132
    s_branch L_mk_fin
L_mk_ps0:
    s_mov_b32 s51, 0x400000
    v_mov_b32 v144, 161744
L_mk_pg0:
    ds_read_b128 v[140:143], v144
    s_waitcnt lgkmcnt(0)
    v_min3_u32 v140, v140, v141, v142
    v_min_u32 v140, v140, v143
    s_sub_u32 s51, s51, 1
    v_readfirstlane_b32 s49, v140
    s_cmp_eq_u32 s51, 0
    s_cbranch_scc1 L_mk_pg0go
    s_cmp_ge_u32 s49, s50
    s_cbranch_scc1 L_mk_pg0go
    s_sleep 1
    s_branch L_mk_pg0
L_mk_pg0go:
    s_branch L_mk_pb0
L_mk_slow:
    s_mov_b32 s58, 1
    s_waitcnt vmcnt(0) lgkmcnt(0)
    v_mov_b32 v140, 0xff800000
    v_mov_b32 v141, 0xff800000
    s_mov_b32 s45, s59
    s_mov_b32 s47, 64
L_mk_mx:
    buffer_load_dwordx4 v[108:111], v2, s[36:39], s45 offen sc1
    s_add_u32 s45, s45, 2048
    s_waitcnt vmcnt(0)
    v_mfma_f32_32x32x16_bf16 v[76:91], v[108:111], v[4:7], 0
    v_mfma_f32_32x32x16_bf16 v[92:107], v[108:111], v[8:11], 0
    s_nop 10
    v_max3_f32 v140, v140, v76, v77
    v_max3_f32 v140, v140, v78, v79
    v_max3_f32 v140, v140, v80, v81
    v_max3_f32 v140, v140, v82, v83
    v_max3_f32 v140, v140, v84, v85
    v_max3_f32 v140, v140, v86, v87
    v_max3_f32 v140, v140, v88, v89
    v_max3_f32 v140, v140, v90, v91
    v_max3_f32 v141, v141, v92, v93
    v_max3_f32 v141, v141, v94, v95
    v_max3_f32 v141, v141, v96, v97
    v_max3_f32 v141, v141, v98, v99
    v_max3_f32 v141, v141, v100, v101
    v_max3_f32 v141, v141, v102, v103
    v_max3_f32 v141, v141, v104, v105
    v_max3_f32 v141, v141, v106, v107
    s_sub_u32 s47, s47, 1
    s_cmp_lg_u32 s47, 0
    s_cbranch_scc1 L_mk_mx
    v_mov_b32 v142, v140
    v_mov_b32 v143, v141
    s_nop 0
    v_permlane32_swap_b32 v142, v140
    v_permlane32_swap_b32 v143, v141
    s_nop 1
    v_max_f32 v140, v140, v142
    v_max_f32 v141, v141, v143
    v_pk_mul_f32 v[44:45], v[140:141], -1.0 op_sel_hi:[0,0]
    v_pk_mul_f32 v[46:47], v[140:141], -1.0 op_sel_hi:[0,0]
    v_pk_mul_f32 v[48:49], v[140:141], -1.0 op_sel_hi:[0,0]
    v_pk_mul_f32 v[50:51], v[140:141], -1.0 op_sel_hi:[0,0]
    v_pk_mul_f32 v[52:53], v[140:141], -1.0 op_sel_hi:[0,0]
    v_pk_mul_f32 v[54:55], v[140:141], -1.0 op_sel_hi:[0,0]
    v_pk_mul_f32 v[56:57], v[140:141], -1.0 op_sel_hi:[0,0]
    v_pk_mul_f32 v[58:59], v[140:141], -1.0 op_sel_hi:[0,0]
    v_pk_mul_f32 v[60:61], v[140:141], -1.0 op_sel:[1,0] op_sel_hi:[1,0]
    v_pk_mul_f32 v[62:63], v[140:141], -1.0 op_sel:[1,0] op_sel_hi:[1,0]
    v_pk_mul_f32 v[64:65], v[140:141], -1.0 op_sel:[1,0] op_sel_hi:[1,0]
    v_pk_mul_f32 v[66:67], v[140:141], -1.0 op_sel:[1,0] op_sel_hi:[1,0]
    v_pk_mul_f32 v[68:69], v[140:141], -1.0 op_sel:[1,0] op_sel_hi:[1,0]
    v_pk_mul_f32 v[70:71], v[140:141], -1.0 op_sel:[1,0] op_sel_hi:[1,0]
    v_pk_mul_f32 v[72:73], v[140:141], -1.0 op_sel:[1,0] op_sel_hi:[1,0]
    v_pk_mul_f32 v[74:75], v[140:141], -1.0 op_sel:[1,0] op_sel_hi:[1,0]
    v_mov_b32 v12, 0
    v_mov_b32 v13, 0
    v_mov_b32 v14, 0
    v_mov_b32 v15, 0
    v_mov_b32 v16, 0
    v_mov_b32 v17, 0
    v_mov_b32 v18, 0
    v_mov_b32 v19, 0
    v_mov_b32 v20, 0
    v_mov_b32 v21, 0
    v_mov_b32 v22, 0
    v_mov_b32 v23, 0
    v_mov_b32 v24, 0
    v_mov_b32 v25, 0
    v_mov_b32 v26, 0
    v_mov_b32 v27, 0
    v_mov_b32 v28, 0
    v_mov_b32 v29, 0
    v_mov_b32 v30, 0
    v_mov_b32 v31, 0
    v_mov_b32 v32, 0
    v_mov_b32 v33, 0
    v_mov_b32 v34, 0
    v_mov_b32 v35, 0
    v_mov_b32 v36, 0
    v_mov_b32 v37, 0
    v_mov_b32 v38, 0
    v_mov_b32 v39, 0
    v_mov_b32 v40, 0
    v_mov_b32 v41, 0
    v_mov_b32 v42, 0
    v_mov_b32 v43, 0
    v_mov_b32 v116, 0x3f803f80
    v_mov_b32 v117, 0x3f803f80
    v_mov_b32 v118, 0x3f803f80
    v_mov_b32 v119, 0x3f803f80
    v_mov_b32 v120, 0x3f803f80
    v_mov_b32 v121, 0x3f803f80
    v_mov_b32 v122, 0x3f803f80
    v_mov_b32 v123, 0x3f803f80
    v_and_b32 v140, 15, v1
    v_lshlrev_b32 v140, 5, v140
    v_lshrrev_b32 v141, 5, v1
    v_lshl_add_u32 v134, v141, 9, v140
    s_mov_b32 s45, s59
    s_mov_b32 s47, 64
    s_mov_b32 s52, 0xffff
    s_mov_b32 s53, 0xffff
L_mk_redo:
    buffer_load_dwordx4 v[108:111], v2, s[36:39], s45 offen sc1
    s_mov_b64 exec, s[52:53]
    buffer_load_dwordx4 v[116:119], v134, s[36:39], s45 offen offset:1024 sc1
    buffer_load_dwordx4 v[120:123], v134, s[36:39], s45 offen offset:1040 sc1
    s_mov_b64 exec, -1
    s_add_u32 s45, s45, 2048
    s_waitcnt vmcnt(0)
    v_mfma_f32_32x32x16_bf16 v[76:91], v[108:111], v[4:7], v[44:59]
    v_mfma_f32_32x32x16_bf16 v[92:107], v[108:111], v[8:11], v[60:75]
    s_nop 10
    v_exp_f32 v76, v76
    v_exp_f32 v77, v77
    v_exp_f32 v78, v78
    v_exp_f32 v79, v79
    v_exp_f32 v80, v80
    v_exp_f32 v81, v81
    v_exp_f32 v82, v82
    v_exp_f32 v83, v83
    v_exp_f32 v84, v84
    v_exp_f32 v85, v85
    v_exp_f32 v86, v86
    v_exp_f32 v87, v87
    v_exp_f32 v88, v88
    v_exp_f32 v89, v89
    v_exp_f32 v90, v90
    v_exp_f32 v91, v91
    v_exp_f32 v92, v92
    v_exp_f32 v93, v93
    v_exp_f32 v94, v94
    v_exp_f32 v95, v95
    v_exp_f32 v96, v96
    v_exp_f32 v97, v97
    v_exp_f32 v98, v98
    v_exp_f32 v99, v99
    v_exp_f32 v100, v100
    v_exp_f32 v101, v101
    v_exp_f32 v102, v102
    v_exp_f32 v103, v103
    v_exp_f32 v104, v104
    v_exp_f32 v105, v105
    v_exp_f32 v106, v106
    v_exp_f32 v107, v107
    v_smfmac_f32_32x32x32_bf16 v[12:27], v[116:119], v[76:83], v132
    v_smfmac_f32_32x32x32_bf16 v[12:27], v[120:123], v[84:91], v132
    v_smfmac_f32_32x32x32_bf16 v[28:43], v[116:119], v[92:99], v132
    v_smfmac_f32_32x32x32_bf16 v[28:43], v[120:123], v[100:107], v132
    s_nop 7
    s_sub_u32 s47, s47, 1
    s_cmp_lg_u32 s47, 0
    s_cbranch_scc1 L_mk_redo
L_mk_fin:
    s_setprio 3
    s_lshl_b32 s43, s42, 5
    s_add_u32 s43, s43, s41
    s_lshl_b32 s43, s43, 10
    s_add_u32 s43, s43, 0x1800000
    s_add_u32 s44, s43, 0x8000
    v_rcp_f32 v140, v20
    s_nop 0
    v_pk_mul_f32 v[12:13], v[12:13], v[140:141] op_sel_hi:[1,0]
    v_pk_mul_f32 v[14:15], v[14:15], v[140:141] op_sel_hi:[1,0]
    v_pk_mul_f32 v[16:17], v[16:17], v[140:141] op_sel_hi:[1,0]
    v_pk_mul_f32 v[18:19], v[18:19], v[140:141] op_sel_hi:[1,0]
    v_cvt_pk_bf16_f32 v144, v12, v13
    v_cvt_pk_bf16_f32 v145, v14, v15
    v_cvt_pk_bf16_f32 v146, v16, v17
    v_cvt_pk_bf16_f32 v147, v18, v19
    buffer_store_dwordx4 v[144:147], v2, s[36:39], s43 offen sc1
    v_rcp_f32 v142, v36
    s_nop 0
    v_pk_mul_f32 v[28:29], v[28:29], v[142:143] op_sel_hi:[1,0]
    v_pk_mul_f32 v[30:31], v[30:31], v[142:143] op_sel_hi:[1,0]
    v_pk_mul_f32 v[32:33], v[32:33], v[142:143] op_sel_hi:[1,0]
    v_pk_mul_f32 v[34:35], v[34:35], v[142:143] op_sel_hi:[1,0]
    v_cvt_pk_bf16_f32 v148, v28, v29
    v_cvt_pk_bf16_f32 v149, v30, v31
    v_cvt_pk_bf16_f32 v150, v32, v33
    v_cvt_pk_bf16_f32 v151, v34, v35
    buffer_store_dwordx4 v[148:151], v2, s[36:39], s44 offen sc1
    v_min_f32 v140, v20, v36
    v_add_f32 v141, v20, v36
    v_pk_mul_f32 v[142:143], v[12:13], 0
    v_pk_fma_f32 v[142:143], v[14:15], 0, v[142:143]
    v_pk_fma_f32 v[142:143], v[16:17], 0, v[142:143]
    v_pk_fma_f32 v[142:143], v[18:19], 0, v[142:143]
    v_pk_fma_f32 v[142:143], v[28:29], 0, v[142:143]
    v_pk_fma_f32 v[142:143], v[30:31], 0, v[142:143]
    v_pk_fma_f32 v[142:143], v[32:33], 0, v[142:143]
    v_pk_fma_f32 v[142:143], v[34:35], 0, v[142:143]
    v_add_f32 v141, v141, v142
    v_add_f32 v141, v141, v143
    s_mov_b32 s52, 0x5d800000
    s_mov_b32 s53, 0x21800000
    v_cmp_nge_f32 vcc, s52, v141
    v_cmp_nle_f32 s[54:55], s53, v140
    s_nop 1
    s_or_b64 vcc, vcc, s[54:55]
    s_cmp_eq_u32 s58, 1
    s_cbranch_scc1 L_mk_ok
    s_cbranch_vccnz L_mk_slow
L_mk_ok:
    s_lshl_b32 s43, s42, 7
    s_add_u32 s43, s43, 0xd89000
    s_and_b32 s41, s2, 7
    s_lshl_b32 s41, s41, 2
    s_bfe_u32 s42, s2, 0x20003
    s_add_u32 s41, s41, s42
    s_lshr_b32 s42, s2, 5
    s_lshl_b32 s41, s41, 1
    s_lshl_b32 s42, s42, 1
    s_lshl_b32 s45, s40, 13
    s_lshl_b32 s52, s42, 15
    s_add_u32 s52, s52, s45
    s_add_u32 s52, s52, 0x880000
    s_add_u32 s53, s52, 0x8000
    s_add_u32 s54, s52, 4096
    s_add_u32 s55, s53, 4096
    s_lshl_b32 s44, s41, 15
    s_add_u32 s44, s44, s45
    s_add_u32 s44, s44, 0x1800000
    s_add_u32 s45, s44, 0x8000
    s_add_u32 s46, s44, 4096
    s_add_u32 s47, s45, 4096
    s_lshl_b32 s61, s41, 7
    s_add_u32 s61, s61, 0xd89000
    v_mov_b32 v232, 0
    s_mul_i32 s50, s40, 4256
    v_add_u32 v233, s50, v2
    v_mov_b32 v234, 1
    v_mov_b32 v235, 0
    s_waitcnt vmcnt(0)
    s_mov_b64 exec, 1
    buffer_atomic_add v234, v235, s[36:39], s43 offen sc1
    s_mov_b64 exec, -1
    s_setprio 0
    s_mov_b32 s51, 0x400000
    v_mov_b32 v237, 161836
L_mk_wfa:
    ds_read_b32 v236, v237
    s_waitcnt lgkmcnt(0)
    s_sub_u32 s51, s51, 1
    v_readfirstlane_b32 s49, v236
    s_cmp_eq_u32 s51, 0
    s_cbranch_scc1 L_mk_wfago
    s_cmp_ge_u32 s49, 1
    s_cbranch_scc1 L_mk_wfago
    s_sleep 1
    s_branch L_mk_wfa
L_mk_wfago:
    buffer_load_dwordx4 v[160:163], v2, s[36:39], s52 offen offset:0 sc1
    buffer_load_dwordx4 v[164:167], v2, s[36:39], s53 offen offset:0 sc1
    buffer_load_dwordx4 v[168:171], v2, s[36:39], s52 offen offset:1024 sc1
    buffer_load_dwordx4 v[172:175], v2, s[36:39], s53 offen offset:1024 sc1
    buffer_load_dwordx4 v[176:179], v2, s[36:39], s52 offen offset:2048 sc1
    buffer_load_dwordx4 v[180:183], v2, s[36:39], s53 offen offset:2048 sc1
    buffer_load_dwordx4 v[184:187], v2, s[36:39], s52 offen offset:3072 sc1
    buffer_load_dwordx4 v[188:191], v2, s[36:39], s53 offen offset:3072 sc1
    buffer_load_dwordx4 v[192:195], v2, s[36:39], s54 offen offset:0 sc1
    buffer_load_dwordx4 v[196:199], v2, s[36:39], s55 offen offset:0 sc1
    buffer_load_dwordx4 v[200:203], v2, s[36:39], s54 offen offset:1024 sc1
    buffer_load_dwordx4 v[204:207], v2, s[36:39], s55 offen offset:1024 sc1
    buffer_load_dwordx4 v[208:211], v2, s[36:39], s54 offen offset:2048 sc1
    buffer_load_dwordx4 v[212:215], v2, s[36:39], s55 offen offset:2048 sc1
    buffer_load_dwordx4 v[216:219], v2, s[36:39], s54 offen offset:3072 sc1
    buffer_load_dwordx4 v[220:223], v2, s[36:39], s55 offen offset:3072 sc1
    s_mov_b32 s51, 0x400000
    v_mov_b32 v240, 161760
L_mk_p64:
    ds_read_b128 v[236:239], v240
    s_waitcnt lgkmcnt(0)
    v_min3_u32 v236, v236, v237, v238
    v_min_u32 v236, v236, v239
    s_sub_u32 s51, s51, 1
    v_readfirstlane_b32 s49, v236
    s_cmp_eq_u32 s51, 0
    s_cbranch_scc1 L_mk_p64go
    s_cmp_ge_u32 s49, 64
    s_cbranch_scc1 L_mk_p64go
    s_sleep 1
    s_branch L_mk_p64
L_mk_p64go:
    s_mov_b32 s51, 0x400000
    v_mov_b32 v237, 161828
L_mk_c4l:
    ds_read_b32 v236, v237
    s_waitcnt lgkmcnt(0)
    s_sub_u32 s51, s51, 1
    v_readfirstlane_b32 s49, v236
    s_cmp_eq_u32 s51, 0
    s_cbranch_scc1 L_mk_c4lgo
    s_cmp_ge_u32 s49, 4
    s_cbranch_scc1 L_mk_c4lgo
    s_sleep 2
    s_branch L_mk_c4l
L_mk_c4lgo:
    s_mov_b32 s51, 0x40000
    s_cmp_lg_u32 s40, 0
    s_cbranch_scc1 L_mk_opolll
    s_mov_b64 exec, 1
L_mk_opoll:
    v_mov_b32 v236, 0
    buffer_atomic_add v236, v232, s[36:39], s61 offen sc0 sc1
    s_sub_u32 s51, s51, 1
    s_cmp_eq_u32 s51, 0
    s_waitcnt vmcnt(0)
    s_cbranch_scc1 L_mk_opollset
    v_cmp_gt_u32 vcc, 32, v236
    s_nop 4
    s_cbranch_vccz L_mk_opollset
    s_sleep 3
    s_branch L_mk_opoll
L_mk_opollset:
    s_mov_b64 exec, -1
    v_mov_b32 v236, 161784
    v_mov_b32 v237, 1
    ds_write_b32 v236, v237
    s_branch L_mk_opollwgo
L_mk_opolll:
    s_mov_b32 s51, 0x400000
    v_mov_b32 v237, 161784
L_mk_opollw:
    ds_read_b32 v236, v237
    s_waitcnt lgkmcnt(0)
    s_sub_u32 s51, s51, 1
    v_readfirstlane_b32 s49, v236
    s_cmp_eq_u32 s51, 0
    s_cbranch_scc1 L_mk_opollwgo
    s_cmp_ge_u32 s49, 1
    s_cbranch_scc1 L_mk_opollwgo
    s_sleep 2
    s_branch L_mk_opollw
L_mk_opollwgo:
    buffer_load_dwordx4 v[68:71], v2, s[36:39], s44 offen offset:0 sc1
    buffer_load_dwordx4 v[72:75], v2, s[36:39], s45 offen offset:0 sc1
    buffer_load_dwordx4 v[76:79], v2, s[36:39], s44 offen offset:1024 sc1
    buffer_load_dwordx4 v[80:83], v2, s[36:39], s45 offen offset:1024 sc1
    buffer_load_dwordx4 v[84:87], v2, s[36:39], s44 offen offset:2048 sc1
    buffer_load_dwordx4 v[88:91], v2, s[36:39], s45 offen offset:2048 sc1
    buffer_load_dwordx4 v[92:95], v2, s[36:39], s44 offen offset:3072 sc1
    buffer_load_dwordx4 v[96:99], v2, s[36:39], s45 offen offset:3072 sc1
    buffer_load_dwordx4 v[100:103], v2, s[36:39], s46 offen offset:0 sc1
    buffer_load_dwordx4 v[104:107], v2, s[36:39], s47 offen offset:0 sc1
    buffer_load_dwordx4 v[108:111], v2, s[36:39], s46 offen offset:1024 sc1
    buffer_load_dwordx4 v[112:115], v2, s[36:39], s47 offen offset:1024 sc1
    buffer_load_dwordx4 v[116:119], v2, s[36:39], s46 offen offset:2048 sc1
    buffer_load_dwordx4 v[120:123], v2, s[36:39], s47 offen offset:2048 sc1
    buffer_load_dwordx4 v[124:127], v2, s[36:39], s46 offen offset:3072 sc1
    buffer_load_dwordx4 v[128:131], v2, s[36:39], s47 offen offset:3072 sc1
    s_waitcnt vmcnt(14)
    v_mfma_f32_32x32x16_bf16 v[4:19], v[160:163], v[68:71], 0
    v_mfma_f32_32x32x16_bf16 v[20:35], v[160:163], v[72:75], 0
    v_mfma_f32_32x32x16_bf16 v[36:51], v[164:167], v[68:71], 0
    v_mfma_f32_32x32x16_bf16 v[52:67], v[164:167], v[72:75], 0
    s_waitcnt vmcnt(12)
    v_mfma_f32_32x32x16_bf16 v[4:19], v[168:171], v[76:79], v[4:19]
    v_mfma_f32_32x32x16_bf16 v[20:35], v[168:171], v[80:83], v[20:35]
    v_mfma_f32_32x32x16_bf16 v[36:51], v[172:175], v[76:79], v[36:51]
    v_mfma_f32_32x32x16_bf16 v[52:67], v[172:175], v[80:83], v[52:67]
    s_waitcnt vmcnt(10)
    v_mfma_f32_32x32x16_bf16 v[4:19], v[176:179], v[84:87], v[4:19]
    v_mfma_f32_32x32x16_bf16 v[20:35], v[176:179], v[88:91], v[20:35]
    v_mfma_f32_32x32x16_bf16 v[36:51], v[180:183], v[84:87], v[36:51]
    v_mfma_f32_32x32x16_bf16 v[52:67], v[180:183], v[88:91], v[52:67]
    s_waitcnt vmcnt(8)
    v_mfma_f32_32x32x16_bf16 v[4:19], v[184:187], v[92:95], v[4:19]
    v_mfma_f32_32x32x16_bf16 v[20:35], v[184:187], v[96:99], v[20:35]
    v_mfma_f32_32x32x16_bf16 v[36:51], v[188:191], v[92:95], v[36:51]
    v_mfma_f32_32x32x16_bf16 v[52:67], v[188:191], v[96:99], v[52:67]
    s_waitcnt vmcnt(6)
    v_mfma_f32_32x32x16_bf16 v[4:19], v[192:195], v[100:103], v[4:19]
    v_mfma_f32_32x32x16_bf16 v[20:35], v[192:195], v[104:107], v[20:35]
    v_mfma_f32_32x32x16_bf16 v[36:51], v[196:199], v[100:103], v[36:51]
    v_mfma_f32_32x32x16_bf16 v[52:67], v[196:199], v[104:107], v[52:67]
    s_waitcnt vmcnt(4)
    v_mfma_f32_32x32x16_bf16 v[4:19], v[200:203], v[108:111], v[4:19]
    v_mfma_f32_32x32x16_bf16 v[20:35], v[200:203], v[112:115], v[20:35]
    v_mfma_f32_32x32x16_bf16 v[36:51], v[204:207], v[108:111], v[36:51]
    v_mfma_f32_32x32x16_bf16 v[52:67], v[204:207], v[112:115], v[52:67]
    s_waitcnt vmcnt(2)
    v_mfma_f32_32x32x16_bf16 v[4:19], v[208:211], v[116:119], v[4:19]
    v_mfma_f32_32x32x16_bf16 v[20:35], v[208:211], v[120:123], v[20:35]
    v_mfma_f32_32x32x16_bf16 v[36:51], v[212:215], v[116:119], v[36:51]
    v_mfma_f32_32x32x16_bf16 v[52:67], v[212:215], v[120:123], v[52:67]
    s_waitcnt vmcnt(0)
    v_mfma_f32_32x32x16_bf16 v[4:19], v[216:219], v[124:127], v[4:19]
    v_mfma_f32_32x32x16_bf16 v[20:35], v[216:219], v[128:131], v[20:35]
    v_mfma_f32_32x32x16_bf16 v[36:51], v[220:223], v[124:127], v[36:51]
    v_mfma_f32_32x32x16_bf16 v[52:67], v[220:223], v[128:131], v[52:67]
    s_nop 8
    ds_write_b128 v233, v[4:7] offset:0
    ds_write_b128 v233, v[8:11] offset:1024
    ds_write_b128 v233, v[12:15] offset:2128
    ds_write_b128 v233, v[16:19] offset:3152
    ds_write_b128 v233, v[20:23] offset:17024
    ds_write_b128 v233, v[24:27] offset:18048
    ds_write_b128 v233, v[28:31] offset:19152
    ds_write_b128 v233, v[32:35] offset:20176
    ds_write_b128 v233, v[36:39] offset:34048
    ds_write_b128 v233, v[40:43] offset:35072
    ds_write_b128 v233, v[44:47] offset:36176
    ds_write_b128 v233, v[48:51] offset:37200
    ds_write_b128 v233, v[52:55] offset:51072
    ds_write_b128 v233, v[56:59] offset:52096
    ds_write_b128 v233, v[60:63] offset:53200
    ds_write_b128 v233, v[64:67] offset:54224
    s_waitcnt lgkmcnt(0)
    v_mov_b32 v234, 161824
    v_mov_b32 v235, 1
    s_mov_b64 exec, 1
    ds_add_u32 v234, v235
    s_mov_b64 exec, -1
    s_endpgm
L_text_end:
.section .rodata,"a"
.p2align 6
.amdhsa_kernel gated_mix__softmax_full_mha__mixer_s_mlp__prompt_kernel
  .amdhsa_next_free_vgpr 256
  .amdhsa_next_free_sgpr 100
  .amdhsa_accum_offset 256
  .amdhsa_group_segment_fixed_size 0
  .amdhsa_kernarg_size 96
  .amdhsa_user_sgpr_count 2
  .amdhsa_user_sgpr_kernarg_segment_ptr 1
  .amdhsa_system_sgpr_workgroup_id_x 1
.end_amdhsa_kernel
```
